```python
import torch

def _softmax(x, axis=-1):
    return torch.softmax(x, dim=axis)
def _gelu(x):
    return torch.nn.functional.gelu(x, approximate="tanh")
def _silu(x):
    return torch.nn.functional.silu(x)
def _sigmoid(x):
    return torch.sigmoid(x)
def _layernorm(x, axis=-1, eps=1e-5):
    m = x.mean(dim=axis, keepdim=True)
    v = x.var(dim=axis, keepdim=True, unbiased=False)
    return (x - m) / torch.sqrt(v + eps)
def _scatter_add(tgt, idx, src, axis=0):
    return tgt.clone().index_add_(axis, idx, src)
def _segment_sum(src, seg, n):
    out = torch.zeros((n,) + src.shape[1:], dtype=src.dtype)
    return out.index_add_(0, seg, src)
def _pad(x, pw):
    flat = tuple(v for pair in reversed(pw) for v in pair)
    return torch.nn.functional.pad(x, flat)

kernel_name = 'gather_scatter__molecular_angular_gemnet__graph'

def setup_inputs():

    _w = (lambda a: (lambda t: t.to(torch.bfloat16) if t.is_floating_point() else t)(torch.as_tensor(a)))
    N, deg, De, L = 50000, 16, 16, 2
    E = N * deg
    T = E * deg
    NR = 8
    dist = torch.rand(E).to(float)
    angle = (torch.rand(T) * torch.pi).to(float)
    centers = torch.linspace(0.0, 1.0, NR).to(float)
    ang_freq = torch.arange(1, L + 1).to(float)
    return {
        "m": _w((lambda *s: torch.randn(*s, dtype=torch.bfloat16) * 0.05)(E, De)),
        "idx_in": _w((lambda lo, hi, *s: torch.randint(lo, hi, s))(0, E, T).to(torch.int64)),
        "idx_out": _w((lambda lo, hi, *s: torch.randint(lo, hi, s))(0, E, T).to(torch.int64)),
        "dist": _w(dist),
        "angle": _w(angle),
        "centers": _w(centers),
        "ang_freq": _w(ang_freq),
        "w_rbf": _w((lambda *s: torch.randn(*s, dtype=torch.bfloat16) * 0.2)(NR, De)),
        "w_sbf": _w((lambda *s: torch.randn(*s, dtype=torch.bfloat16) * 0.2)(NR * L, De)),
        "w_down": _w((lambda *s: torch.randn(*s, dtype=torch.bfloat16) * 0.2)(De, De)),
        "w_up": _w((lambda *s: torch.randn(*s, dtype=torch.bfloat16) * 0.2)(De, De)),
    }

def reference(m, idx_in, idx_out, dist, angle, centers, ang_freq, w_rbf, w_sbf, w_down, w_up):
    E, De = m.shape[0], m.shape[1]
    NR = centers.shape[0]
    L = ang_freq.shape[0]
    rbf = torch.exp(-10.0 * (dist[:, None] - centers[None, :]) ** 2)
    cbf = torch.cos(ang_freq[None, :] * angle[:, None])
    rbf_t = rbf[idx_out]
    sbf = torch.reshape(rbf_t[:, :, None] * cbf[:, None, :], (-1, NR * L))
    x = (m[idx_in] @ w_down) * (sbf @ w_sbf)
    agg = _segment_sum(x, idx_out, E)
    return m + (agg @ w_up) * (rbf @ w_rbf)
```

```asm
; @launch grid=(256,1,1) block=(1024,1,1) lds=163840
.amdgcn_target "amdgcn-amd-amdhsa--gfx950"
.text
.globl gather_scatter__molecular_angular_gemnet__graph_kernel
.p2align 8
.type gather_scatter__molecular_angular_gemnet__graph_kernel,@function
gather_scatter__molecular_angular_gemnet__graph_kernel:
    s_cmp_ge_u32 s2, 256
    s_cbranch_scc1 P2_done
    s_load_dwordx4 s[4:7], s[0:1], 8
    s_load_dwordx2 s[42:43], s[0:1], 32
    s_load_dwordx2 s[44:45], s[0:1], 104
    s_load_dwordx2 s[70:71], s[0:1], 0
    s_load_dwordx2 s[84:85], s[0:1], 24
    s_load_dwordx2 s[86:87], s[0:1], 96
    v_lshlrev_b32 v1, 4, v0
    v_lshlrev_b32 v31, 3, v0
    v_mov_b32 v2, 1
    v_mov_b32 v3, 0x7fffff00
    s_mov_b32 s28, 1374390
    s_mov_b32 s29, -3125
    s_mov_b32 s31, 0xffff0000
    s_mov_b32 s32, -155904
    v_lshrrev_b32 v8, 6, v0
    v_mov_b32 v4, 0
    v_mov_b32 v5, 0
    v_mov_b32 v6, 0
    v_mov_b32 v7, 0
    v_readfirstlane_b32 s35, v8
    s_mov_b32 s30, 0
    v_add_u32 v9, 0, v1
    v_mov_b32 v10, 12
    ds_write_b128 v9, v[4:7] offset:16
    ds_write_b32 v10, v4
    s_waitcnt lgkmcnt(0)
    s_mov_b32 s8, s4
    s_and_b32 s9, s5, 0xffff
    s_mov_b32 s10, 51200000
    s_mov_b32 s11, 0x20000
    s_mov_b32 s12, s6
    s_and_b32 s13, s7, 0xffff
    s_mov_b32 s14, 51200000
    s_mov_b32 s15, 0x20000
    s_mov_b32 s16, s42
    s_and_b32 s17, s43, 0xffff
    s_mov_b32 s18, 25600000
    s_mov_b32 s19, 0x20000
    s_mov_b32 s20, s44
    s_and_b32 s21, s45, 0xffff
    s_mov_b32 s22, 76808192
    s_mov_b32 s23, 0x20000
    s_add_u32 s44, s44, 76808192
    s_addc_u32 s45, s45, 0
    s_mov_b32 s24, s44
    s_and_b32 s25, s45, 0xffff
    s_mov_b32 s26, 4202496
    s_mov_b32 s27, 0x20000
    s_bfe_u32 s36, s2, 131074
    s_lshl_b32 s36, s36, 4
    s_mov_b32 s72, 0x4a073a07
    s_mov_b32 s73, 0x4b174b07
    s_lshr_b64 s[72:73], s[72:73], s36
    s_and_b32 s46, s72, 0xffff
    s_mul_i32 s46, s46, 0x10001
    s_mul_i32 s33, s2, 200000
    s_mul_i32 s34, s2, 100000
    s_lshl_b32 s36, s2, 4
    s_add_u32 s68, s36, s35
    s_cmp_eq_u32 s68, 15
    s_cbranch_scc0 P1_now
    s_load_dwordx4 s[72:75], s[0:1], 56
    s_load_dwordx4 s[76:79], s[0:1], 72
    v_and_b32 v4, 63, v0
    v_and_b32 v6, 3, v0
    v_bfe_u32 v7, v0, 2, 1
    v_lshl_add_u32 v6, v7, 3, v6
    v_bfe_u32 v7, v0, 3, 1
    v_lshl_add_u32 v6, v7, 2, v6
    v_lshlrev_b32 v5, 1, v6
    v_lshrrev_b32 v7, 5, v4
    v_lshl_add_u32 v7, v7, 8, v5
    s_waitcnt lgkmcnt(0)
    s_mov_b32 s80, s76
    s_and_b32 s81, s77, 0xffff
    s_mov_b32 s82, 512
    s_mov_b32 s83, 0x20000
    buffer_load_ushort v96, v5, s[80:83], 0 offen offset:0
    buffer_load_ushort v97, v5, s[80:83], 0 offen offset:32
    buffer_load_ushort v98, v5, s[80:83], 0 offen offset:64
    buffer_load_ushort v99, v5, s[80:83], 0 offen offset:96
    buffer_load_ushort v100, v5, s[80:83], 0 offen offset:128
    buffer_load_ushort v101, v5, s[80:83], 0 offen offset:160
    buffer_load_ushort v102, v5, s[80:83], 0 offen offset:192
    buffer_load_ushort v103, v5, s[80:83], 0 offen offset:224
    buffer_load_ushort v104, v5, s[80:83], 0 offen offset:256
    buffer_load_ushort v105, v5, s[80:83], 0 offen offset:288
    buffer_load_ushort v106, v5, s[80:83], 0 offen offset:320
    buffer_load_ushort v107, v5, s[80:83], 0 offen offset:352
    buffer_load_ushort v108, v5, s[80:83], 0 offen offset:384
    buffer_load_ushort v109, v5, s[80:83], 0 offen offset:416
    buffer_load_ushort v110, v5, s[80:83], 0 offen offset:448
    buffer_load_ushort v111, v5, s[80:83], 0 offen offset:480
    s_mov_b32 s80, s74
    s_and_b32 s81, s75, 0xffff
    s_mov_b32 s82, 512
    s_mov_b32 s83, 0x20000
    buffer_load_ushort v112, v5, s[80:83], 0 offen offset:0
    buffer_load_ushort v113, v5, s[80:83], 0 offen offset:32
    buffer_load_ushort v114, v5, s[80:83], 0 offen offset:64
    buffer_load_ushort v115, v5, s[80:83], 0 offen offset:96
    buffer_load_ushort v116, v5, s[80:83], 0 offen offset:128
    buffer_load_ushort v117, v5, s[80:83], 0 offen offset:160
    buffer_load_ushort v118, v5, s[80:83], 0 offen offset:192
    buffer_load_ushort v119, v5, s[80:83], 0 offen offset:224
    buffer_load_ushort v120, v5, s[80:83], 0 offen offset:256
    buffer_load_ushort v121, v5, s[80:83], 0 offen offset:288
    buffer_load_ushort v122, v5, s[80:83], 0 offen offset:320
    buffer_load_ushort v123, v5, s[80:83], 0 offen offset:352
    buffer_load_ushort v124, v5, s[80:83], 0 offen offset:384
    buffer_load_ushort v125, v5, s[80:83], 0 offen offset:416
    buffer_load_ushort v126, v5, s[80:83], 0 offen offset:448
    buffer_load_ushort v127, v5, s[80:83], 0 offen offset:480
    s_mov_b32 s80, s78
    s_and_b32 s81, s79, 0xffff
    s_mov_b32 s82, 512
    s_mov_b32 s83, 0x20000
    buffer_load_ushort v48, v7, s[80:83], 0 offen offset:0
    buffer_load_ushort v49, v7, s[80:83], 0 offen offset:32
    buffer_load_ushort v50, v7, s[80:83], 0 offen offset:64
    buffer_load_ushort v51, v7, s[80:83], 0 offen offset:96
    buffer_load_ushort v52, v7, s[80:83], 0 offen offset:128
    buffer_load_ushort v53, v7, s[80:83], 0 offen offset:160
    buffer_load_ushort v54, v7, s[80:83], 0 offen offset:192
    buffer_load_ushort v55, v7, s[80:83], 0 offen offset:224
    s_mov_b32 s80, s72
    s_and_b32 s81, s73, 0xffff
    s_mov_b32 s82, 256
    s_mov_b32 s83, 0x20000
    buffer_load_ushort v56, v5, s[80:83], 0 offen offset:0
    buffer_load_ushort v57, v5, s[80:83], 0 offen offset:32
    buffer_load_ushort v58, v5, s[80:83], 0 offen offset:64
    buffer_load_ushort v59, v5, s[80:83], 0 offen offset:96
    buffer_load_ushort v60, v5, s[80:83], 0 offen offset:128
    buffer_load_ushort v61, v5, s[80:83], 0 offen offset:160
    buffer_load_ushort v62, v5, s[80:83], 0 offen offset:192
    buffer_load_ushort v63, v5, s[80:83], 0 offen offset:224
P1_now:
    buffer_load_dwordx4 v[32:35], v1, s[12:15], s33 offen nt
    buffer_load_dwordx4 v[80:83], v1, s[8:11], s33 offen nt
    s_add_u32 s33, s33, 16384
    s_cmp_eq_u32 s68, 15
    s_cbranch_scc0 P1_noop
    s_waitcnt vmcnt(2)
    v_lshlrev_b32 v96, 16, v96
    v_lshlrev_b32 v97, 16, v97
    v_lshlrev_b32 v98, 16, v98
    v_lshlrev_b32 v99, 16, v99
    v_lshlrev_b32 v100, 16, v100
    v_lshlrev_b32 v101, 16, v101
    v_lshlrev_b32 v102, 16, v102
    v_lshlrev_b32 v103, 16, v103
    v_lshlrev_b32 v104, 16, v104
    v_lshlrev_b32 v105, 16, v105
    v_lshlrev_b32 v106, 16, v106
    v_lshlrev_b32 v107, 16, v107
    v_lshlrev_b32 v108, 16, v108
    v_lshlrev_b32 v109, 16, v109
    v_lshlrev_b32 v110, 16, v110
    v_lshlrev_b32 v111, 16, v111
    v_lshlrev_b32 v112, 16, v112
    v_lshlrev_b32 v113, 16, v113
    v_lshlrev_b32 v114, 16, v114
    v_lshlrev_b32 v115, 16, v115
    v_lshlrev_b32 v116, 16, v116
    v_lshlrev_b32 v117, 16, v117
    v_lshlrev_b32 v118, 16, v118
    v_lshlrev_b32 v119, 16, v119
    v_lshlrev_b32 v120, 16, v120
    v_lshlrev_b32 v121, 16, v121
    v_lshlrev_b32 v122, 16, v122
    v_lshlrev_b32 v123, 16, v123
    v_lshlrev_b32 v124, 16, v124
    v_lshlrev_b32 v125, 16, v125
    v_lshlrev_b32 v126, 16, v126
    v_lshlrev_b32 v127, 16, v127
    v_lshlrev_b32 v48, 16, v48
    v_lshlrev_b32 v49, 16, v49
    v_lshlrev_b32 v50, 16, v50
    v_lshlrev_b32 v51, 16, v51
    v_lshlrev_b32 v52, 16, v52
    v_lshlrev_b32 v53, 16, v53
    v_lshlrev_b32 v54, 16, v54
    v_lshlrev_b32 v55, 16, v55
    v_lshlrev_b32 v56, 16, v56
    v_lshlrev_b32 v57, 16, v57
    v_lshlrev_b32 v58, 16, v58
    v_lshlrev_b32 v59, 16, v59
    v_lshlrev_b32 v60, 16, v60
    v_lshlrev_b32 v61, 16, v61
    v_lshlrev_b32 v62, 16, v62
    v_lshlrev_b32 v63, 16, v63
    v_lshrrev_b32 v12, 1, v4
    v_xor_b32 v12, v12, v4
    v_and_b32 v12, 16, v12
    v_cmp_eq_u32 s[72:73], 0, v12
    v_and_b32 v12, 16, v4
    v_cmp_eq_u32 s[74:75], 0, v12
    v_cmp_eq_u32 s[76:77], 16, v12
    v_and_b32 v12, 48, v4
    v_cmp_eq_u32 s[78:79], 16, v12
    v_lshlrev_b32 v13, 4, v4
    v_max3_f32 v6, abs(v112), abs(v113), abs(v114)
    v_max3_f32 v6, v6, abs(v115), abs(v116)
    v_max3_f32 v6, v6, abs(v117), abs(v118)
    v_max3_f32 v6, v6, abs(v119), abs(v120)
    v_max3_f32 v6, v6, abs(v121), abs(v122)
    v_max3_f32 v6, v6, abs(v123), abs(v124)
    v_max3_f32 v6, v6, abs(v125), abs(v126)
    v_max_f32 v6, v6, abs(v127)
    v_bfe_u32 v6, v6, 23, 8
    v_cmp_eq_u32 vcc, 0, v6
    v_sub_u32 v6, 141, v6
    s_nop 0
    v_cndmask_b32 v6, v6, 0, vcc
    v_sub_u32 v7, 0, v6
    v_ldexp_f32 v112, v112, v6
    v_ldexp_f32 v96, v96, v7
    v_ldexp_f32 v113, v113, v6
    v_ldexp_f32 v97, v97, v7
    v_ldexp_f32 v114, v114, v6
    v_ldexp_f32 v98, v98, v7
    v_ldexp_f32 v115, v115, v6
    v_ldexp_f32 v99, v99, v7
    v_ldexp_f32 v116, v116, v6
    v_ldexp_f32 v100, v100, v7
    v_ldexp_f32 v117, v117, v6
    v_ldexp_f32 v101, v101, v7
    v_ldexp_f32 v118, v118, v6
    v_ldexp_f32 v102, v102, v7
    v_ldexp_f32 v119, v119, v6
    v_ldexp_f32 v103, v103, v7
    v_ldexp_f32 v120, v120, v6
    v_ldexp_f32 v104, v104, v7
    v_ldexp_f32 v121, v121, v6
    v_ldexp_f32 v105, v105, v7
    v_ldexp_f32 v122, v122, v6
    v_ldexp_f32 v106, v106, v7
    v_ldexp_f32 v123, v123, v6
    v_ldexp_f32 v107, v107, v7
    v_ldexp_f32 v124, v124, v6
    v_ldexp_f32 v108, v108, v7
    v_ldexp_f32 v125, v125, v6
    v_ldexp_f32 v109, v109, v7
    v_ldexp_f32 v126, v126, v6
    v_ldexp_f32 v110, v110, v7
    v_ldexp_f32 v127, v127, v6
    v_ldexp_f32 v111, v111, v7
    v_max3_f32 v6, abs(v56), abs(v57), abs(v58)
    v_max3_f32 v6, v6, abs(v59), abs(v60)
    v_max3_f32 v6, v6, abs(v61), abs(v62)
    v_max_f32 v6, v6, abs(v63)
    v_bfe_u32 v6, v6, 23, 8
    v_cmp_eq_u32 vcc, 0, v6
    v_sub_u32 v6, 141, v6
    s_nop 0
    v_cndmask_b32 v6, v6, 0, vcc
    v_sub_u32 v7, 0, v6
    v_ldexp_f32 v56, v56, v6
    v_ldexp_f32 v48, v48, v7
    v_ldexp_f32 v57, v57, v6
    v_ldexp_f32 v49, v49, v7
    v_ldexp_f32 v58, v58, v6
    v_ldexp_f32 v50, v50, v7
    v_ldexp_f32 v59, v59, v6
    v_ldexp_f32 v51, v51, v7
    v_ldexp_f32 v60, v60, v6
    v_ldexp_f32 v52, v52, v7
    v_ldexp_f32 v61, v61, v6
    v_ldexp_f32 v53, v53, v7
    v_ldexp_f32 v62, v62, v6
    v_ldexp_f32 v54, v54, v7
    v_ldexp_f32 v63, v63, v6
    v_ldexp_f32 v55, v55, v7
    v_cvt_pk_bf16_f32 v8, v96, v97
    v_cvt_pk_bf16_f32 v9, v98, v99
    v_cvt_pk_bf16_f32 v10, v100, v101
    v_cvt_pk_bf16_f32 v11, v102, v103
    v_cndmask_b32 v8, 0, v8, s[72:73]
    v_cndmask_b32 v9, 0, v9, s[72:73]
    v_cndmask_b32 v10, 0, v10, s[72:73]
    v_cndmask_b32 v11, 0, v11, s[72:73]
    s_mov_b32 s36, 4194304
    buffer_store_dwordx4 v[8:11], v13, s[24:27], s36 offen sc1
    s_nop 1
    v_cvt_pk_bf16_f32 v8, v104, v105
    v_cvt_pk_bf16_f32 v9, v106, v107
    v_cvt_pk_bf16_f32 v10, v108, v109
    v_cvt_pk_bf16_f32 v11, v110, v111
    v_cndmask_b32 v8, 0, v8, s[72:73]
    v_cndmask_b32 v9, 0, v9, s[72:73]
    v_cndmask_b32 v10, 0, v10, s[72:73]
    v_cndmask_b32 v11, 0, v11, s[72:73]
    s_mov_b32 s36, 4195328
    buffer_store_dwordx4 v[8:11], v13, s[24:27], s36 offen sc1
    s_nop 1
    v_cvt_pk_f16_f32 v8, v112, v114
    v_cvt_pk_f16_f32 v9, v116, v118
    v_cvt_pk_f16_f32 v10, v120, v122
    v_cvt_pk_f16_f32 v11, v124, v126
    v_cndmask_b32 v8, 0, v8, s[72:73]
    v_cndmask_b32 v9, 0, v9, s[72:73]
    v_cndmask_b32 v10, 0, v10, s[72:73]
    v_cndmask_b32 v11, 0, v11, s[72:73]
    s_mov_b32 s36, 4196352
    buffer_store_dwordx4 v[8:11], v13, s[24:27], s36 offen sc1
    s_nop 1
    v_cvt_pk_f16_f32 v8, v113, v115
    v_cvt_pk_f16_f32 v9, v117, v119
    v_cvt_pk_f16_f32 v10, v121, v123
    v_cvt_pk_f16_f32 v11, v125, v127
    v_cndmask_b32 v8, 0, v8, s[72:73]
    v_cndmask_b32 v9, 0, v9, s[72:73]
    v_cndmask_b32 v10, 0, v10, s[72:73]
    v_cndmask_b32 v11, 0, v11, s[72:73]
    s_mov_b32 s36, 4197376
    buffer_store_dwordx4 v[8:11], v13, s[24:27], s36 offen sc1
    s_nop 1
    v_cvt_pk_bf16_f32 v8, v48, v49
    v_cvt_pk_bf16_f32 v9, v50, v51
    v_cvt_pk_bf16_f32 v10, v52, v53
    v_cvt_pk_bf16_f32 v11, v54, v55
    v_cndmask_b32 v8, 0, v8, s[74:75]
    v_cndmask_b32 v9, 0, v9, s[74:75]
    v_cndmask_b32 v10, 0, v10, s[74:75]
    v_cndmask_b32 v11, 0, v11, s[74:75]
    s_mov_b32 s36, 4200448
    buffer_store_dwordx4 v[8:11], v13, s[24:27], s36 offen sc1
    s_nop 1
    v_cvt_pk_f16_f32 v8, v56, v57
    v_cvt_pk_f16_f32 v9, v58, v59
    v_cvt_pk_f16_f32 v10, v60, v61
    v_cvt_pk_f16_f32 v11, v62, v63
    v_cndmask_b32 v8, 0, v8, s[78:79]
    v_cndmask_b32 v9, 0, v9, s[78:79]
    v_cndmask_b32 v10, 0, v10, s[78:79]
    v_cndmask_b32 v11, 0, v11, s[78:79]
    s_mov_b32 s36, 4201472
    buffer_store_dwordx4 v[8:11], v13, s[24:27], s36 offen sc1
    s_nop 1
    v_lshrrev_b32 v6, 1, v5
    v_lshrrev_b32 v7, 5, v4
    v_lshlrev_b32 v7, 3, v7
    v_sub_u32 v6, v6, v7
    v_cmp_eq_u32 vcc, 0, v6
    s_nop 1
    v_cndmask_b32 v96, 0, 1.0, vcc
    v_cmp_eq_u32 vcc, 1, v6
    s_nop 1
    v_cndmask_b32 v97, 0, 1.0, vcc
    v_cmp_eq_u32 vcc, 2, v6
    s_nop 1
    v_cndmask_b32 v98, 0, 1.0, vcc
    v_cmp_eq_u32 vcc, 3, v6
    s_nop 1
    v_cndmask_b32 v99, 0, 1.0, vcc
    v_cmp_eq_u32 vcc, 4, v6
    s_nop 1
    v_cndmask_b32 v100, 0, 1.0, vcc
    v_cmp_eq_u32 vcc, 5, v6
    s_nop 1
    v_cndmask_b32 v101, 0, 1.0, vcc
    v_cmp_eq_u32 vcc, 6, v6
    s_nop 1
    v_cndmask_b32 v102, 0, 1.0, vcc
    v_cmp_eq_u32 vcc, 7, v6
    s_nop 1
    v_cndmask_b32 v103, 0, 1.0, vcc
    v_cvt_pk_bf16_f32 v8, v96, v97
    v_cvt_pk_bf16_f32 v9, v98, v99
    v_cvt_pk_bf16_f32 v10, v100, v101
    v_cvt_pk_bf16_f32 v11, v102, v103
    v_cndmask_b32 v8, 0, v8, s[74:75]
    v_cndmask_b32 v9, 0, v9, s[74:75]
    v_cndmask_b32 v10, 0, v10, s[74:75]
    v_cndmask_b32 v11, 0, v11, s[74:75]
    s_mov_b32 s36, 4198400
    buffer_store_dwordx4 v[8:11], v13, s[24:27], s36 offen sc1
    s_nop 1
P1_noop:
    s_barrier
    s_waitcnt vmcnt(0)
    v_mul_hi_u32_u24 v4, s28, v32
    v_mul_u32_u24 v6, 272, v80
    v_mul_hi_u32_u24 v5, s28, v33
    v_mul_u32_u24 v7, 272, v81
    v_mad_i32_i24 v32, v4, s29, v32
    v_lshrrev_b32 v8, 5, v4
    v_lshrrev_b32 v6, 24, v6
    v_lshlrev_b32 v8, 2, v8
    v_lshl_add_u32 v4, v4, 2, s30
    v_bfe_u32 v8, s46, v8, 4
    v_lshl_or_b32 v80, v80, 12, v32
    v_sub_u32 v6, v6, v8
    v_add_u32 v8, 13, v6
    v_min_u32 v6, v6, v8
    v_lshl_add_u32 v32, v6, 10, v4
    ds_add_u32 v32, v2 offset:16
    v_mad_i32_i24 v33, v5, s29, v33
    v_lshrrev_b32 v9, 5, v5
    v_lshrrev_b32 v7, 24, v7
    v_lshlrev_b32 v9, 2, v9
    v_lshl_add_u32 v5, v5, 2, s30
    v_bfe_u32 v9, s46, v9, 4
    v_lshl_or_b32 v81, v81, 12, v33
    v_sub_u32 v7, v7, v9
    v_add_u32 v9, 13, v7
    v_min_u32 v7, v7, v9
    v_lshl_add_u32 v33, v7, 10, v5
    ds_add_u32 v33, v2 offset:16
    v_mul_hi_u32_u24 v4, s28, v34
    v_mul_u32_u24 v6, 272, v82
    v_mul_hi_u32_u24 v5, s28, v35
    v_mul_u32_u24 v7, 272, v83
    v_mad_i32_i24 v34, v4, s29, v34
    v_lshrrev_b32 v8, 5, v4
    v_lshrrev_b32 v6, 24, v6
    v_lshlrev_b32 v8, 2, v8
    v_lshl_add_u32 v4, v4, 2, s30
    v_bfe_u32 v8, s46, v8, 4
    v_lshl_or_b32 v82, v82, 12, v34
    v_sub_u32 v6, v6, v8
    v_add_u32 v8, 13, v6
    v_min_u32 v6, v6, v8
    v_lshl_add_u32 v34, v6, 10, v4
    ds_add_u32 v34, v2 offset:16
    v_mad_i32_i24 v35, v5, s29, v35
    v_lshrrev_b32 v9, 5, v5
    v_lshrrev_b32 v7, 24, v7
    v_lshlrev_b32 v9, 2, v9
    v_lshl_add_u32 v5, v5, 2, s30
    v_bfe_u32 v9, s46, v9, 4
    v_lshl_or_b32 v83, v83, 12, v35
    v_sub_u32 v7, v7, v9
    v_add_u32 v9, 13, v7
    v_min_u32 v7, v7, v9
    v_lshl_add_u32 v35, v7, 10, v5
    ds_add_u32 v35, v2 offset:16
    buffer_load_dwordx4 v[36:39], v1, s[12:15], s33 offen nt
    buffer_load_dwordx4 v[84:87], v1, s[8:11], s33 offen nt
    s_add_u32 s33, s33, 16384
    s_waitcnt vmcnt(0)
    v_mul_hi_u32_u24 v4, s28, v36
    v_mul_u32_u24 v6, 272, v84
    v_mul_hi_u32_u24 v5, s28, v37
    v_mul_u32_u24 v7, 272, v85
    v_mad_i32_i24 v36, v4, s29, v36
    v_lshrrev_b32 v8, 5, v4
    v_lshrrev_b32 v6, 24, v6
    v_lshlrev_b32 v8, 2, v8
    v_lshl_add_u32 v4, v4, 2, s30
    v_bfe_u32 v8, s46, v8, 4
    v_lshl_or_b32 v84, v84, 12, v36
    v_sub_u32 v6, v6, v8
    v_add_u32 v8, 13, v6
    v_min_u32 v6, v6, v8
    v_lshl_add_u32 v36, v6, 10, v4
    ds_add_u32 v36, v2 offset:16
    v_mad_i32_i24 v37, v5, s29, v37
    v_lshrrev_b32 v9, 5, v5
    v_lshrrev_b32 v7, 24, v7
    v_lshlrev_b32 v9, 2, v9
    v_lshl_add_u32 v5, v5, 2, s30
    v_bfe_u32 v9, s46, v9, 4
    v_lshl_or_b32 v85, v85, 12, v37
    v_sub_u32 v7, v7, v9
    v_add_u32 v9, 13, v7
    v_min_u32 v7, v7, v9
    v_lshl_add_u32 v37, v7, 10, v5
    ds_add_u32 v37, v2 offset:16
    v_mul_hi_u32_u24 v4, s28, v38
    v_mul_u32_u24 v6, 272, v86
    v_mul_hi_u32_u24 v5, s28, v39
    v_mul_u32_u24 v7, 272, v87
    v_mad_i32_i24 v38, v4, s29, v38
    v_lshrrev_b32 v8, 5, v4
    v_lshrrev_b32 v6, 24, v6
    v_lshlrev_b32 v8, 2, v8
    v_lshl_add_u32 v4, v4, 2, s30
    v_bfe_u32 v8, s46, v8, 4
    v_lshl_or_b32 v86, v86, 12, v38
    v_sub_u32 v6, v6, v8
    v_add_u32 v8, 13, v6
    v_min_u32 v6, v6, v8
    v_lshl_add_u32 v38, v6, 10, v4
    ds_add_u32 v38, v2 offset:16
    v_mad_i32_i24 v39, v5, s29, v39
    v_lshrrev_b32 v9, 5, v5
    v_lshrrev_b32 v7, 24, v7
    v_lshlrev_b32 v9, 2, v9
    v_lshl_add_u32 v5, v5, 2, s30
    v_bfe_u32 v9, s46, v9, 4
    v_lshl_or_b32 v87, v87, 12, v39
    v_sub_u32 v7, v7, v9
    v_add_u32 v9, 13, v7
    v_min_u32 v7, v7, v9
    v_lshl_add_u32 v39, v7, 10, v5
    ds_add_u32 v39, v2 offset:16
    buffer_load_dwordx4 v[40:43], v1, s[12:15], s33 offen nt
    buffer_load_dwordx4 v[88:91], v1, s[8:11], s33 offen nt
    s_add_u32 s33, s33, 16384
    s_waitcnt vmcnt(0)
    v_mul_hi_u32_u24 v4, s28, v40
    v_mul_u32_u24 v6, 272, v88
    v_mul_hi_u32_u24 v5, s28, v41
    v_mul_u32_u24 v7, 272, v89
    v_mad_i32_i24 v40, v4, s29, v40
    v_lshrrev_b32 v8, 5, v4
    v_lshrrev_b32 v6, 24, v6
    v_lshlrev_b32 v8, 2, v8
    v_lshl_add_u32 v4, v4, 2, s30
    v_bfe_u32 v8, s46, v8, 4
    v_lshl_or_b32 v88, v88, 12, v40
    v_sub_u32 v6, v6, v8
    v_add_u32 v8, 13, v6
    v_min_u32 v6, v6, v8
    v_lshl_add_u32 v40, v6, 10, v4
    ds_add_u32 v40, v2 offset:16
    v_mad_i32_i24 v41, v5, s29, v41
    v_lshrrev_b32 v9, 5, v5
    v_lshrrev_b32 v7, 24, v7
    v_lshlrev_b32 v9, 2, v9
    v_lshl_add_u32 v5, v5, 2, s30
    v_bfe_u32 v9, s46, v9, 4
    v_lshl_or_b32 v89, v89, 12, v41
    v_sub_u32 v7, v7, v9
    v_add_u32 v9, 13, v7
    v_min_u32 v7, v7, v9
    v_lshl_add_u32 v41, v7, 10, v5
    ds_add_u32 v41, v2 offset:16
    v_mul_hi_u32_u24 v4, s28, v42
    v_mul_u32_u24 v6, 272, v90
    v_mul_hi_u32_u24 v5, s28, v43
    v_mul_u32_u24 v7, 272, v91
    v_mad_i32_i24 v42, v4, s29, v42
    v_lshrrev_b32 v8, 5, v4
    v_lshrrev_b32 v6, 24, v6
    v_lshlrev_b32 v8, 2, v8
    v_lshl_add_u32 v4, v4, 2, s30
    v_bfe_u32 v8, s46, v8, 4
    v_lshl_or_b32 v90, v90, 12, v42
    v_sub_u32 v6, v6, v8
    v_add_u32 v8, 13, v6
    v_min_u32 v6, v6, v8
    v_lshl_add_u32 v42, v6, 10, v4
    ds_add_u32 v42, v2 offset:16
    v_mad_i32_i24 v43, v5, s29, v43
    v_lshrrev_b32 v9, 5, v5
    v_lshrrev_b32 v7, 24, v7
    v_lshlrev_b32 v9, 2, v9
    v_lshl_add_u32 v5, v5, 2, s30
    v_bfe_u32 v9, s46, v9, 4
    v_lshl_or_b32 v91, v91, 12, v43
    v_sub_u32 v7, v7, v9
    v_add_u32 v9, 13, v7
    v_min_u32 v7, v7, v9
    v_lshl_add_u32 v43, v7, 10, v5
    ds_add_u32 v43, v2 offset:16
    buffer_load_dwordx4 v[44:47], v1, s[12:15], s33 offen nt
    buffer_load_dwordx4 v[92:95], v1, s[8:11], s33 offen nt
    s_add_u32 s33, s33, 16384
    s_waitcnt vmcnt(0)
    v_mul_hi_u32_u24 v4, s28, v44
    v_mul_u32_u24 v6, 272, v92
    v_mul_hi_u32_u24 v5, s28, v45
    v_mul_u32_u24 v7, 272, v93
    v_mad_i32_i24 v44, v4, s29, v44
    v_lshrrev_b32 v8, 5, v4
    v_lshrrev_b32 v6, 24, v6
    v_lshlrev_b32 v8, 2, v8
    v_lshl_add_u32 v4, v4, 2, s30
    v_bfe_u32 v8, s46, v8, 4
    v_lshl_or_b32 v92, v92, 12, v44
    v_sub_u32 v6, v6, v8
    v_add_u32 v8, 13, v6
    v_min_u32 v6, v6, v8
    v_lshl_add_u32 v44, v6, 10, v4
    ds_add_u32 v44, v2 offset:16
    v_mad_i32_i24 v45, v5, s29, v45
    v_lshrrev_b32 v9, 5, v5
    v_lshrrev_b32 v7, 24, v7
    v_lshlrev_b32 v9, 2, v9
    v_lshl_add_u32 v5, v5, 2, s30
    v_bfe_u32 v9, s46, v9, 4
    v_lshl_or_b32 v93, v93, 12, v45
    v_sub_u32 v7, v7, v9
    v_add_u32 v9, 13, v7
    v_min_u32 v7, v7, v9
    v_lshl_add_u32 v45, v7, 10, v5
    ds_add_u32 v45, v2 offset:16
    v_mul_hi_u32_u24 v4, s28, v46
    v_mul_u32_u24 v6, 272, v94
    v_mul_hi_u32_u24 v5, s28, v47
    v_mul_u32_u24 v7, 272, v95
    v_mad_i32_i24 v46, v4, s29, v46
    v_lshrrev_b32 v8, 5, v4
    v_lshrrev_b32 v6, 24, v6
    v_lshlrev_b32 v8, 2, v8
    v_lshl_add_u32 v4, v4, 2, s30
    v_bfe_u32 v8, s46, v8, 4
    v_lshl_or_b32 v94, v94, 12, v46
    v_sub_u32 v6, v6, v8
    v_add_u32 v8, 13, v6
    v_min_u32 v6, v6, v8
    v_lshl_add_u32 v46, v6, 10, v4
    ds_add_u32 v46, v2 offset:16
    v_mad_i32_i24 v47, v5, s29, v47
    v_lshrrev_b32 v9, 5, v5
    v_lshrrev_b32 v7, 24, v7
    v_lshlrev_b32 v9, 2, v9
    v_lshl_add_u32 v5, v5, 2, s30
    v_bfe_u32 v9, s46, v9, 4
    v_lshl_or_b32 v95, v95, 12, v47
    v_sub_u32 v7, v7, v9
    v_add_u32 v9, 13, v7
    v_min_u32 v7, v7, v9
    v_lshl_add_u32 v47, v7, 10, v5
    ds_add_u32 v47, v2 offset:16
    buffer_load_dwordx4 v[48:51], v1, s[12:15], s33 offen nt
    buffer_load_dwordx4 v[96:99], v1, s[8:11], s33 offen nt
    s_add_u32 s33, s33, 16384
    s_waitcnt vmcnt(0)
    v_mul_hi_u32_u24 v4, s28, v48
    v_mul_u32_u24 v6, 272, v96
    v_mul_hi_u32_u24 v5, s28, v49
    v_mul_u32_u24 v7, 272, v97
    v_mad_i32_i24 v48, v4, s29, v48
    v_lshrrev_b32 v8, 5, v4
    v_lshrrev_b32 v6, 24, v6
    v_lshlrev_b32 v8, 2, v8
    v_lshl_add_u32 v4, v4, 2, s30
    v_bfe_u32 v8, s46, v8, 4
    v_lshl_or_b32 v96, v96, 12, v48
    v_sub_u32 v6, v6, v8
    v_add_u32 v8, 13, v6
    v_min_u32 v6, v6, v8
    v_lshl_add_u32 v48, v6, 10, v4
    ds_add_u32 v48, v2 offset:16
    v_mad_i32_i24 v49, v5, s29, v49
    v_lshrrev_b32 v9, 5, v5
    v_lshrrev_b32 v7, 24, v7
    v_lshlrev_b32 v9, 2, v9
    v_lshl_add_u32 v5, v5, 2, s30
    v_bfe_u32 v9, s46, v9, 4
    v_lshl_or_b32 v97, v97, 12, v49
    v_sub_u32 v7, v7, v9
    v_add_u32 v9, 13, v7
    v_min_u32 v7, v7, v9
    v_lshl_add_u32 v49, v7, 10, v5
    ds_add_u32 v49, v2 offset:16
    v_mul_hi_u32_u24 v4, s28, v50
    v_mul_u32_u24 v6, 272, v98
    v_mul_hi_u32_u24 v5, s28, v51
    v_mul_u32_u24 v7, 272, v99
    v_mad_i32_i24 v50, v4, s29, v50
    v_lshrrev_b32 v8, 5, v4
    v_lshrrev_b32 v6, 24, v6
    v_lshlrev_b32 v8, 2, v8
    v_lshl_add_u32 v4, v4, 2, s30
    v_bfe_u32 v8, s46, v8, 4
    v_lshl_or_b32 v98, v98, 12, v50
    v_sub_u32 v6, v6, v8
    v_add_u32 v8, 13, v6
    v_min_u32 v6, v6, v8
    v_lshl_add_u32 v50, v6, 10, v4
    ds_add_u32 v50, v2 offset:16
    v_mad_i32_i24 v51, v5, s29, v51
    v_lshrrev_b32 v9, 5, v5
    v_lshrrev_b32 v7, 24, v7
    v_lshlrev_b32 v9, 2, v9
    v_lshl_add_u32 v5, v5, 2, s30
    v_bfe_u32 v9, s46, v9, 4
    v_lshl_or_b32 v99, v99, 12, v51
    v_sub_u32 v7, v7, v9
    v_add_u32 v9, 13, v7
    v_min_u32 v7, v7, v9
    v_lshl_add_u32 v51, v7, 10, v5
    ds_add_u32 v51, v2 offset:16
    buffer_load_dwordx4 v[52:55], v1, s[12:15], s33 offen nt
    buffer_load_dwordx4 v[100:103], v1, s[8:11], s33 offen nt
    s_add_u32 s33, s33, 16384
    s_waitcnt vmcnt(0)
    v_mul_hi_u32_u24 v4, s28, v52
    v_mul_u32_u24 v6, 272, v100
    v_mul_hi_u32_u24 v5, s28, v53
    v_mul_u32_u24 v7, 272, v101
    v_mad_i32_i24 v52, v4, s29, v52
    v_lshrrev_b32 v8, 5, v4
    v_lshrrev_b32 v6, 24, v6
    v_lshlrev_b32 v8, 2, v8
    v_lshl_add_u32 v4, v4, 2, s30
    v_bfe_u32 v8, s46, v8, 4
    v_lshl_or_b32 v100, v100, 12, v52
    v_sub_u32 v6, v6, v8
    v_add_u32 v8, 13, v6
    v_min_u32 v6, v6, v8
    v_lshl_add_u32 v52, v6, 10, v4
    ds_add_u32 v52, v2 offset:16
    v_mad_i32_i24 v53, v5, s29, v53
    v_lshrrev_b32 v9, 5, v5
    v_lshrrev_b32 v7, 24, v7
    v_lshlrev_b32 v9, 2, v9
    v_lshl_add_u32 v5, v5, 2, s30
    v_bfe_u32 v9, s46, v9, 4
    v_lshl_or_b32 v101, v101, 12, v53
    v_sub_u32 v7, v7, v9
    v_add_u32 v9, 13, v7
    v_min_u32 v7, v7, v9
    v_lshl_add_u32 v53, v7, 10, v5
    ds_add_u32 v53, v2 offset:16
    v_mul_hi_u32_u24 v4, s28, v54
    v_mul_u32_u24 v6, 272, v102
    v_mul_hi_u32_u24 v5, s28, v55
    v_mul_u32_u24 v7, 272, v103
    v_mad_i32_i24 v54, v4, s29, v54
    v_lshrrev_b32 v8, 5, v4
    v_lshrrev_b32 v6, 24, v6
    v_lshlrev_b32 v8, 2, v8
    v_lshl_add_u32 v4, v4, 2, s30
    v_bfe_u32 v8, s46, v8, 4
    v_lshl_or_b32 v102, v102, 12, v54
    v_sub_u32 v6, v6, v8
    v_add_u32 v8, 13, v6
    v_min_u32 v6, v6, v8
    v_lshl_add_u32 v54, v6, 10, v4
    ds_add_u32 v54, v2 offset:16
    v_mad_i32_i24 v55, v5, s29, v55
    v_lshrrev_b32 v9, 5, v5
    v_lshrrev_b32 v7, 24, v7
    v_lshlrev_b32 v9, 2, v9
    v_lshl_add_u32 v5, v5, 2, s30
    v_bfe_u32 v9, s46, v9, 4
    v_lshl_or_b32 v103, v103, 12, v55
    v_sub_u32 v7, v7, v9
    v_add_u32 v9, 13, v7
    v_min_u32 v7, v7, v9
    v_lshl_add_u32 v55, v7, 10, v5
    ds_add_u32 v55, v2 offset:16
    buffer_load_dwordx4 v[56:59], v1, s[12:15], s33 offen nt
    buffer_load_dwordx4 v[104:107], v1, s[8:11], s33 offen nt
    s_add_u32 s33, s33, 16384
    s_waitcnt vmcnt(0)
    v_mul_hi_u32_u24 v4, s28, v56
    v_mul_u32_u24 v6, 272, v104
    v_mul_hi_u32_u24 v5, s28, v57
    v_mul_u32_u24 v7, 272, v105
    v_mad_i32_i24 v56, v4, s29, v56
    v_lshrrev_b32 v8, 5, v4
    v_lshrrev_b32 v6, 24, v6
    v_lshlrev_b32 v8, 2, v8
    v_lshl_add_u32 v4, v4, 2, s30
    v_bfe_u32 v8, s46, v8, 4
    v_lshl_or_b32 v104, v104, 12, v56
    v_sub_u32 v6, v6, v8
    v_add_u32 v8, 13, v6
    v_min_u32 v6, v6, v8
    v_lshl_add_u32 v56, v6, 10, v4
    ds_add_u32 v56, v2 offset:16
    v_mad_i32_i24 v57, v5, s29, v57
    v_lshrrev_b32 v9, 5, v5
    v_lshrrev_b32 v7, 24, v7
    v_lshlrev_b32 v9, 2, v9
    v_lshl_add_u32 v5, v5, 2, s30
    v_bfe_u32 v9, s46, v9, 4
    v_lshl_or_b32 v105, v105, 12, v57
    v_sub_u32 v7, v7, v9
    v_add_u32 v9, 13, v7
    v_min_u32 v7, v7, v9
    v_lshl_add_u32 v57, v7, 10, v5
    ds_add_u32 v57, v2 offset:16
    v_mul_hi_u32_u24 v4, s28, v58
    v_mul_u32_u24 v6, 272, v106
    v_mul_hi_u32_u24 v5, s28, v59
    v_mul_u32_u24 v7, 272, v107
    v_mad_i32_i24 v58, v4, s29, v58
    v_lshrrev_b32 v8, 5, v4
    v_lshrrev_b32 v6, 24, v6
    v_lshlrev_b32 v8, 2, v8
    v_lshl_add_u32 v4, v4, 2, s30
    v_bfe_u32 v8, s46, v8, 4
    v_lshl_or_b32 v106, v106, 12, v58
    v_sub_u32 v6, v6, v8
    v_add_u32 v8, 13, v6
    v_min_u32 v6, v6, v8
    v_lshl_add_u32 v58, v6, 10, v4
    ds_add_u32 v58, v2 offset:16
    v_mad_i32_i24 v59, v5, s29, v59
    v_lshrrev_b32 v9, 5, v5
    v_lshrrev_b32 v7, 24, v7
    v_lshlrev_b32 v9, 2, v9
    v_lshl_add_u32 v5, v5, 2, s30
    v_bfe_u32 v9, s46, v9, 4
    v_lshl_or_b32 v107, v107, 12, v59
    v_sub_u32 v7, v7, v9
    v_add_u32 v9, 13, v7
    v_min_u32 v7, v7, v9
    v_lshl_add_u32 v59, v7, 10, v5
    ds_add_u32 v59, v2 offset:16
    buffer_load_dwordx4 v[60:63], v1, s[12:15], s33 offen nt
    buffer_load_dwordx4 v[108:111], v1, s[8:11], s33 offen nt
    s_add_u32 s33, s33, 16384
    s_waitcnt vmcnt(0)
    v_mul_hi_u32_u24 v4, s28, v60
    v_mul_u32_u24 v6, 272, v108
    v_mul_hi_u32_u24 v5, s28, v61
    v_mul_u32_u24 v7, 272, v109
    v_mad_i32_i24 v60, v4, s29, v60
    v_lshrrev_b32 v8, 5, v4
    v_lshrrev_b32 v6, 24, v6
    v_lshlrev_b32 v8, 2, v8
    v_lshl_add_u32 v4, v4, 2, s30
    v_bfe_u32 v8, s46, v8, 4
    v_lshl_or_b32 v108, v108, 12, v60
    v_sub_u32 v6, v6, v8
    v_add_u32 v8, 13, v6
    v_min_u32 v6, v6, v8
    v_lshl_add_u32 v60, v6, 10, v4
    ds_add_u32 v60, v2 offset:16
    v_mad_i32_i24 v61, v5, s29, v61
    v_lshrrev_b32 v9, 5, v5
    v_lshrrev_b32 v7, 24, v7
    v_lshlrev_b32 v9, 2, v9
    v_lshl_add_u32 v5, v5, 2, s30
    v_bfe_u32 v9, s46, v9, 4
    v_lshl_or_b32 v109, v109, 12, v61
    v_sub_u32 v7, v7, v9
    v_add_u32 v9, 13, v7
    v_min_u32 v7, v7, v9
    v_lshl_add_u32 v61, v7, 10, v5
    ds_add_u32 v61, v2 offset:16
    v_mul_hi_u32_u24 v4, s28, v62
    v_mul_u32_u24 v6, 272, v110
    v_mul_hi_u32_u24 v5, s28, v63
    v_mul_u32_u24 v7, 272, v111
    v_mad_i32_i24 v62, v4, s29, v62
    v_lshrrev_b32 v8, 5, v4
    v_lshrrev_b32 v6, 24, v6
    v_lshlrev_b32 v8, 2, v8
    v_lshl_add_u32 v4, v4, 2, s30
    v_bfe_u32 v8, s46, v8, 4
    v_lshl_or_b32 v110, v110, 12, v62
    v_sub_u32 v6, v6, v8
    v_add_u32 v8, 13, v6
    v_min_u32 v6, v6, v8
    v_lshl_add_u32 v62, v6, 10, v4
    ds_add_u32 v62, v2 offset:16
    v_mad_i32_i24 v63, v5, s29, v63
    v_lshrrev_b32 v9, 5, v5
    v_lshrrev_b32 v7, 24, v7
    v_lshlrev_b32 v9, 2, v9
    v_lshl_add_u32 v5, v5, 2, s30
    v_bfe_u32 v9, s46, v9, 4
    v_lshl_or_b32 v111, v111, 12, v63
    v_sub_u32 v7, v7, v9
    v_add_u32 v9, 13, v7
    v_min_u32 v7, v7, v9
    v_lshl_add_u32 v63, v7, 10, v5
    ds_add_u32 v63, v2 offset:16
    buffer_load_dwordx4 v[64:67], v1, s[12:15], s33 offen nt
    buffer_load_dwordx4 v[112:115], v1, s[8:11], s33 offen nt
    s_add_u32 s33, s33, 16384
    s_waitcnt vmcnt(0)
    v_mul_hi_u32_u24 v4, s28, v64
    v_mul_u32_u24 v6, 272, v112
    v_mul_hi_u32_u24 v5, s28, v65
    v_mul_u32_u24 v7, 272, v113
    v_mad_i32_i24 v64, v4, s29, v64
    v_lshrrev_b32 v8, 5, v4
    v_lshrrev_b32 v6, 24, v6
    v_lshlrev_b32 v8, 2, v8
    v_lshl_add_u32 v4, v4, 2, s30
    v_bfe_u32 v8, s46, v8, 4
    v_lshl_or_b32 v112, v112, 12, v64
    v_sub_u32 v6, v6, v8
    v_add_u32 v8, 13, v6
    v_min_u32 v6, v6, v8
    v_lshl_add_u32 v64, v6, 10, v4
    ds_add_u32 v64, v2 offset:16
    v_mad_i32_i24 v65, v5, s29, v65
    v_lshrrev_b32 v9, 5, v5
    v_lshrrev_b32 v7, 24, v7
    v_lshlrev_b32 v9, 2, v9
    v_lshl_add_u32 v5, v5, 2, s30
    v_bfe_u32 v9, s46, v9, 4
    v_lshl_or_b32 v113, v113, 12, v65
    v_sub_u32 v7, v7, v9
    v_add_u32 v9, 13, v7
    v_min_u32 v7, v7, v9
    v_lshl_add_u32 v65, v7, 10, v5
    ds_add_u32 v65, v2 offset:16
    v_mul_hi_u32_u24 v4, s28, v66
    v_mul_u32_u24 v6, 272, v114
    v_mul_hi_u32_u24 v5, s28, v67
    v_mul_u32_u24 v7, 272, v115
    v_mad_i32_i24 v66, v4, s29, v66
    v_lshrrev_b32 v8, 5, v4
    v_lshrrev_b32 v6, 24, v6
    v_lshlrev_b32 v8, 2, v8
    v_lshl_add_u32 v4, v4, 2, s30
    v_bfe_u32 v8, s46, v8, 4
    v_lshl_or_b32 v114, v114, 12, v66
    v_sub_u32 v6, v6, v8
    v_add_u32 v8, 13, v6
    v_min_u32 v6, v6, v8
    v_lshl_add_u32 v66, v6, 10, v4
    ds_add_u32 v66, v2 offset:16
    v_mad_i32_i24 v67, v5, s29, v67
    v_lshrrev_b32 v9, 5, v5
    v_lshrrev_b32 v7, 24, v7
    v_lshlrev_b32 v9, 2, v9
    v_lshl_add_u32 v5, v5, 2, s30
    v_bfe_u32 v9, s46, v9, 4
    v_lshl_or_b32 v115, v115, 12, v67
    v_sub_u32 v7, v7, v9
    v_add_u32 v9, 13, v7
    v_min_u32 v7, v7, v9
    v_lshl_add_u32 v67, v7, 10, v5
    ds_add_u32 v67, v2 offset:16
    buffer_load_dwordx4 v[68:71], v1, s[12:15], s33 offen nt
    buffer_load_dwordx4 v[116:119], v1, s[8:11], s33 offen nt
    s_add_u32 s33, s33, 16384
    s_waitcnt vmcnt(0)
    v_mul_hi_u32_u24 v4, s28, v68
    v_mul_u32_u24 v6, 272, v116
    v_mul_hi_u32_u24 v5, s28, v69
    v_mul_u32_u24 v7, 272, v117
    v_mad_i32_i24 v68, v4, s29, v68
    v_lshrrev_b32 v8, 5, v4
    v_lshrrev_b32 v6, 24, v6
    v_lshlrev_b32 v8, 2, v8
    v_lshl_add_u32 v4, v4, 2, s30
    v_bfe_u32 v8, s46, v8, 4
    v_lshl_or_b32 v116, v116, 12, v68
    v_sub_u32 v6, v6, v8
    v_add_u32 v8, 13, v6
    v_min_u32 v6, v6, v8
    v_lshl_add_u32 v68, v6, 10, v4
    ds_add_u32 v68, v2 offset:16
    v_mad_i32_i24 v69, v5, s29, v69
    v_lshrrev_b32 v9, 5, v5
    v_lshrrev_b32 v7, 24, v7
    v_lshlrev_b32 v9, 2, v9
    v_lshl_add_u32 v5, v5, 2, s30
    v_bfe_u32 v9, s46, v9, 4
    v_lshl_or_b32 v117, v117, 12, v69
    v_sub_u32 v7, v7, v9
    v_add_u32 v9, 13, v7
    v_min_u32 v7, v7, v9
    v_lshl_add_u32 v69, v7, 10, v5
    ds_add_u32 v69, v2 offset:16
    v_mul_hi_u32_u24 v4, s28, v70
    v_mul_u32_u24 v6, 272, v118
    v_mul_hi_u32_u24 v5, s28, v71
    v_mul_u32_u24 v7, 272, v119
    v_mad_i32_i24 v70, v4, s29, v70
    v_lshrrev_b32 v8, 5, v4
    v_lshrrev_b32 v6, 24, v6
    v_lshlrev_b32 v8, 2, v8
    v_lshl_add_u32 v4, v4, 2, s30
    v_bfe_u32 v8, s46, v8, 4
    v_lshl_or_b32 v118, v118, 12, v70
    v_sub_u32 v6, v6, v8
    v_add_u32 v8, 13, v6
    v_min_u32 v6, v6, v8
    v_lshl_add_u32 v70, v6, 10, v4
    ds_add_u32 v70, v2 offset:16
    v_mad_i32_i24 v71, v5, s29, v71
    v_lshrrev_b32 v9, 5, v5
    v_lshrrev_b32 v7, 24, v7
    v_lshlrev_b32 v9, 2, v9
    v_lshl_add_u32 v5, v5, 2, s30
    v_bfe_u32 v9, s46, v9, 4
    v_lshl_or_b32 v119, v119, 12, v71
    v_sub_u32 v7, v7, v9
    v_add_u32 v9, 13, v7
    v_min_u32 v7, v7, v9
    v_lshl_add_u32 v71, v7, 10, v5
    ds_add_u32 v71, v2 offset:16
    buffer_load_dwordx4 v[72:75], v1, s[12:15], s33 offen nt
    buffer_load_dwordx4 v[120:123], v1, s[8:11], s33 offen nt
    s_add_u32 s33, s33, 16384
    s_waitcnt vmcnt(0)
    v_mul_hi_u32_u24 v4, s28, v72
    v_mul_u32_u24 v6, 272, v120
    v_mul_hi_u32_u24 v5, s28, v73
    v_mul_u32_u24 v7, 272, v121
    v_mad_i32_i24 v72, v4, s29, v72
    v_lshrrev_b32 v8, 5, v4
    v_lshrrev_b32 v6, 24, v6
    v_lshlrev_b32 v8, 2, v8
    v_lshl_add_u32 v4, v4, 2, s30
    v_bfe_u32 v8, s46, v8, 4
    v_lshl_or_b32 v120, v120, 12, v72
    v_sub_u32 v6, v6, v8
    v_add_u32 v8, 13, v6
    v_min_u32 v6, v6, v8
    v_lshl_add_u32 v72, v6, 10, v4
    ds_add_u32 v72, v2 offset:16
    v_mad_i32_i24 v73, v5, s29, v73
    v_lshrrev_b32 v9, 5, v5
    v_lshrrev_b32 v7, 24, v7
    v_lshlrev_b32 v9, 2, v9
    v_lshl_add_u32 v5, v5, 2, s30
    v_bfe_u32 v9, s46, v9, 4
    v_lshl_or_b32 v121, v121, 12, v73
    v_sub_u32 v7, v7, v9
    v_add_u32 v9, 13, v7
    v_min_u32 v7, v7, v9
    v_lshl_add_u32 v73, v7, 10, v5
    ds_add_u32 v73, v2 offset:16
    v_mul_hi_u32_u24 v4, s28, v74
    v_mul_u32_u24 v6, 272, v122
    v_mul_hi_u32_u24 v5, s28, v75
    v_mul_u32_u24 v7, 272, v123
    v_mad_i32_i24 v74, v4, s29, v74
    v_lshrrev_b32 v8, 5, v4
    v_lshrrev_b32 v6, 24, v6
    v_lshlrev_b32 v8, 2, v8
    v_lshl_add_u32 v4, v4, 2, s30
    v_bfe_u32 v8, s46, v8, 4
    v_lshl_or_b32 v122, v122, 12, v74
    v_sub_u32 v6, v6, v8
    v_add_u32 v8, 13, v6
    v_min_u32 v6, v6, v8
    v_lshl_add_u32 v74, v6, 10, v4
    ds_add_u32 v74, v2 offset:16
    v_mad_i32_i24 v75, v5, s29, v75
    v_lshrrev_b32 v9, 5, v5
    v_lshrrev_b32 v7, 24, v7
    v_lshlrev_b32 v9, 2, v9
    v_lshl_add_u32 v5, v5, 2, s30
    v_bfe_u32 v9, s46, v9, 4
    v_lshl_or_b32 v123, v123, 12, v75
    v_sub_u32 v7, v7, v9
    v_add_u32 v9, 13, v7
    v_min_u32 v7, v7, v9
    v_lshl_add_u32 v75, v7, 10, v5
    ds_add_u32 v75, v2 offset:16
    buffer_load_dwordx4 v[76:79], v1, s[12:15], s33 offen nt
    buffer_load_dwordx4 v[124:127], v1, s[8:11], s33 offen nt
    s_add_u32 s33, s33, 16384
    s_waitcnt vmcnt(0)
    v_mul_hi_u32_u24 v4, s28, v76
    v_mul_u32_u24 v6, 272, v124
    v_mul_hi_u32_u24 v5, s28, v77
    v_mul_u32_u24 v7, 272, v125
    v_mad_i32_i24 v76, v4, s29, v76
    v_lshrrev_b32 v8, 5, v4
    v_lshrrev_b32 v6, 24, v6
    v_lshlrev_b32 v8, 2, v8
    v_lshl_add_u32 v4, v4, 2, s30
    v_bfe_u32 v8, s46, v8, 4
    v_lshl_or_b32 v124, v124, 12, v76
    v_sub_u32 v6, v6, v8
    v_add_u32 v8, 13, v6
    v_min_u32 v6, v6, v8
    v_lshl_add_u32 v76, v6, 10, v4
    ds_add_u32 v76, v2 offset:16
    v_mad_i32_i24 v77, v5, s29, v77
    v_lshrrev_b32 v9, 5, v5
    v_lshrrev_b32 v7, 24, v7
    v_lshlrev_b32 v9, 2, v9
    v_lshl_add_u32 v5, v5, 2, s30
    v_bfe_u32 v9, s46, v9, 4
    v_lshl_or_b32 v125, v125, 12, v77
    v_sub_u32 v7, v7, v9
    v_add_u32 v9, 13, v7
    v_min_u32 v7, v7, v9
    v_lshl_add_u32 v77, v7, 10, v5
    ds_add_u32 v77, v2 offset:16
    v_mul_hi_u32_u24 v4, s28, v78
    v_mul_u32_u24 v6, 272, v126
    v_mul_hi_u32_u24 v5, s28, v79
    v_mul_u32_u24 v7, 272, v127
    v_mad_i32_i24 v78, v4, s29, v78
    v_lshrrev_b32 v8, 5, v4
    v_lshrrev_b32 v6, 24, v6
    v_lshlrev_b32 v8, 2, v8
    v_lshl_add_u32 v4, v4, 2, s30
    v_bfe_u32 v8, s46, v8, 4
    v_lshl_or_b32 v126, v126, 12, v78
    v_sub_u32 v6, v6, v8
    v_add_u32 v8, 13, v6
    v_min_u32 v6, v6, v8
    v_lshl_add_u32 v78, v6, 10, v4
    ds_add_u32 v78, v2 offset:16
    v_mad_i32_i24 v79, v5, s29, v79
    v_lshrrev_b32 v9, 5, v5
    v_lshrrev_b32 v7, 24, v7
    v_lshlrev_b32 v9, 2, v9
    v_lshl_add_u32 v5, v5, 2, s30
    v_bfe_u32 v9, s46, v9, 4
    v_lshl_or_b32 v127, v127, 12, v79
    v_sub_u32 v7, v7, v9
    v_add_u32 v9, 13, v7
    v_min_u32 v7, v7, v9
    v_lshl_add_u32 v79, v7, 10, v5
    ds_add_u32 v79, v2 offset:16
    v_cmp_gt_u32 vcc, 848, v0
    v_lshlrev_b32 v11, 2, v0
    s_nop 0
    v_cndmask_b32 v11, v3, v11, vcc
    buffer_load_dword v29, v11, s[12:15], s33 offen nt
    buffer_load_dword v30, v11, s[8:11], s33 offen nt
    s_waitcnt vmcnt(0)
    v_cmp_gt_u32 vcc, 848, v0
    s_and_saveexec_b64 s[40:41], vcc
    s_cbranch_execz P1_pk
    v_mul_hi_u32_u24 v4, s28, v29
    v_mul_u32_u24 v6, 272, v30
    v_mad_i32_i24 v29, v4, s29, v29
    v_lshrrev_b32 v8, 5, v4
    v_lshrrev_b32 v6, 24, v6
    v_lshlrev_b32 v8, 2, v8
    v_lshl_add_u32 v4, v4, 2, s30
    v_bfe_u32 v8, s46, v8, 4
    v_lshl_or_b32 v30, v30, 12, v29
    v_sub_u32 v6, v6, v8
    v_add_u32 v8, 13, v6
    v_min_u32 v6, v6, v8
    v_lshl_add_u32 v29, v6, 10, v4
    ds_add_u32 v29, v2 offset:16
P1_pk:
    s_mov_b64 exec, s[40:41]
    s_waitcnt lgkmcnt(0)
    s_barrier
    v_add_u32 v28, 0, v1
    ds_read_b128 v[4:7], v28 offset:16
    buffer_load_dwordx2 v[12:13], v31, s[16:19], s34 offen nt
    s_add_u32 s34, s34, 8192
    buffer_load_dwordx2 v[14:15], v31, s[16:19], s34 offen nt
    s_add_u32 s34, s34, 8192
    buffer_load_dwordx2 v[16:17], v31, s[16:19], s34 offen nt
    s_add_u32 s34, s34, 8192
    buffer_load_dwordx2 v[18:19], v31, s[16:19], s34 offen nt
    s_add_u32 s34, s34, 8192
    s_waitcnt lgkmcnt(0)
    v_add_u32 v8, v4, v5
    v_add3_u32 v8, v8, v6, v7
    v_mov_b32 v9, v8
    s_nop 1
    v_add_u32_dpp v9, v9, v9 row_shr:1 row_mask:0xf bank_mask:0xf bound_ctrl:0
    s_nop 1
    v_add_u32_dpp v9, v9, v9 row_shr:2 row_mask:0xf bank_mask:0xf bound_ctrl:0
    s_nop 1
    v_add_u32_dpp v9, v9, v9 row_shr:4 row_mask:0xf bank_mask:0xf bound_ctrl:0
    s_nop 1
    v_add_u32_dpp v9, v9, v9 row_shr:8 row_mask:0xf bank_mask:0xf bound_ctrl:0
    s_nop 1
    v_add_u32_dpp v9, v9, v9 row_bcast:15 row_mask:0xa bank_mask:0xf
    s_nop 1
    v_add_u32_dpp v9, v9, v9 row_bcast:31 row_mask:0xc bank_mask:0xf
    s_lshl_b32 s37, s35, 2
    s_add_u32 s37, s37, 16400
    v_mov_b32 v11, s37
    v_readlane_b32 s36, v9, 63
    s_nop 1
    v_mov_b32 v10, s36
    ds_write_b32 v11, v10
    v_and_b32 v11, 15, v0
    v_lshlrev_b32 v10, 2, v11
    v_add_u32 v10, 16400, v10
    s_waitcnt lgkmcnt(0)
    s_barrier
    v_cmp_gt_u32 vcc, s35, v11
    ds_read_b32 v10, v10
    buffer_load_dwordx2 v[20:21], v31, s[16:19], s34 offen nt
    s_add_u32 s34, s34, 8192
    buffer_load_dwordx2 v[22:23], v31, s[16:19], s34 offen nt
    s_add_u32 s34, s34, 8192
    buffer_load_dwordx2 v[24:25], v31, s[16:19], s34 offen nt
    s_add_u32 s34, s34, 8192
    buffer_load_dwordx2 v[26:27], v31, s[16:19], s34 offen nt
    s_add_u32 s34, s34, 8192
    s_waitcnt lgkmcnt(0)
    v_cndmask_b32 v10, 0, v10, vcc
    s_nop 1
    v_add_u32_dpp v10, v10, v10 row_shr:1 row_mask:0xf bank_mask:0xf bound_ctrl:0
    s_nop 1
    v_add_u32_dpp v10, v10, v10 row_shr:2 row_mask:0xf bank_mask:0xf bound_ctrl:0
    s_nop 1
    v_add_u32_dpp v10, v10, v10 row_shr:4 row_mask:0xf bank_mask:0xf bound_ctrl:0
    s_nop 1
    v_add_u32_dpp v10, v10, v10 row_shr:8 row_mask:0xf bank_mask:0xf bound_ctrl:0
    v_sub_u32 v9, v9, v8
    v_readlane_b32 s36, v10, 15
    s_nop 1
    v_add_u32 v8, s36, v9
    v_add_u32 v9, v8, v4
    v_add_u32 v10, v9, v5
    v_add_u32 v11, v10, v6
    ds_write_b128 v28, v[8:11] offset:16
    s_waitcnt lgkmcnt(0)
    v_cmp_gt_u32 vcc, 848, v0
    v_lshlrev_b32 v11, 1, v0
    s_nop 0
    v_cndmask_b32 v11, v3, v11, vcc
    s_mul_i32 s36, s2, 100000
    s_add_u32 s36, s36, 98304
    buffer_load_ushort v28, v11, s[16:19], s36 offen nt
    s_barrier
    ds_add_rtn_u32 v32, v32, v2 offset:16
    ds_add_rtn_u32 v33, v33, v2 offset:16
    ds_add_rtn_u32 v34, v34, v2 offset:16
    ds_add_rtn_u32 v35, v35, v2 offset:16
    ds_add_rtn_u32 v36, v36, v2 offset:16
    ds_add_rtn_u32 v37, v37, v2 offset:16
    ds_add_rtn_u32 v38, v38, v2 offset:16
    ds_add_rtn_u32 v39, v39, v2 offset:16
    ds_add_rtn_u32 v40, v40, v2 offset:16
    ds_add_rtn_u32 v41, v41, v2 offset:16
    ds_add_rtn_u32 v42, v42, v2 offset:16
    ds_add_rtn_u32 v43, v43, v2 offset:16
    s_waitcnt lgkmcnt(8)
    s_waitcnt vmcnt(8)
    v_lshl_or_b32 v32, v12, 16, v32
    v_and_or_b32 v33, v12, s31, v33
    v_lshl_or_b32 v34, v13, 16, v34
    v_and_or_b32 v35, v13, s31, v35
    buffer_load_dwordx2 v[12:13], v31, s[16:19], s34 offen nt
    s_add_u32 s34, s34, 8192
    ds_add_rtn_u32 v44, v44, v2 offset:16
    ds_add_rtn_u32 v45, v45, v2 offset:16
    ds_add_rtn_u32 v46, v46, v2 offset:16
    ds_add_rtn_u32 v47, v47, v2 offset:16
    s_waitcnt lgkmcnt(8)
    s_waitcnt vmcnt(8)
    v_lshl_or_b32 v36, v14, 16, v36
    v_and_or_b32 v37, v14, s31, v37
    v_lshl_or_b32 v38, v15, 16, v38
    v_and_or_b32 v39, v15, s31, v39
    buffer_load_dwordx2 v[14:15], v31, s[16:19], s34 offen nt
    s_add_u32 s34, s34, 8192
    ds_add_rtn_u32 v48, v48, v2 offset:16
    ds_add_rtn_u32 v49, v49, v2 offset:16
    ds_add_rtn_u32 v50, v50, v2 offset:16
    ds_add_rtn_u32 v51, v51, v2 offset:16
    s_waitcnt lgkmcnt(8)
    s_waitcnt vmcnt(8)
    v_lshl_or_b32 v40, v16, 16, v40
    v_and_or_b32 v41, v16, s31, v41
    v_lshl_or_b32 v42, v17, 16, v42
    v_and_or_b32 v43, v17, s31, v43
    buffer_load_dwordx2 v[16:17], v31, s[16:19], s34 offen nt
    s_add_u32 s34, s34, 8192
    ds_add_rtn_u32 v52, v52, v2 offset:16
    ds_add_rtn_u32 v53, v53, v2 offset:16
    ds_add_rtn_u32 v54, v54, v2 offset:16
    ds_add_rtn_u32 v55, v55, v2 offset:16
    s_waitcnt lgkmcnt(8)
    s_waitcnt vmcnt(8)
    v_lshl_or_b32 v44, v18, 16, v44
    v_and_or_b32 v45, v18, s31, v45
    v_lshl_or_b32 v46, v19, 16, v46
    v_and_or_b32 v47, v19, s31, v47
    buffer_load_dwordx2 v[18:19], v31, s[16:19], s34 offen nt
    s_add_u32 s34, s34, 8192
    ds_add_rtn_u32 v56, v56, v2 offset:16
    ds_add_rtn_u32 v57, v57, v2 offset:16
    ds_add_rtn_u32 v58, v58, v2 offset:16
    ds_add_rtn_u32 v59, v59, v2 offset:16
    s_waitcnt lgkmcnt(8)
    s_waitcnt vmcnt(8)
    v_lshl_or_b32 v48, v20, 16, v48
    v_and_or_b32 v49, v20, s31, v49
    v_lshl_or_b32 v50, v21, 16, v50
    v_and_or_b32 v51, v21, s31, v51
    ds_add_rtn_u32 v60, v60, v2 offset:16
    ds_add_rtn_u32 v61, v61, v2 offset:16
    ds_add_rtn_u32 v62, v62, v2 offset:16
    ds_add_rtn_u32 v63, v63, v2 offset:16
    s_waitcnt lgkmcnt(8)
    s_waitcnt vmcnt(7)
    v_lshl_or_b32 v52, v22, 16, v52
    v_and_or_b32 v53, v22, s31, v53
    v_lshl_or_b32 v54, v23, 16, v54
    v_and_or_b32 v55, v23, s31, v55
    ds_add_rtn_u32 v64, v64, v2 offset:16
    ds_add_rtn_u32 v65, v65, v2 offset:16
    ds_add_rtn_u32 v66, v66, v2 offset:16
    ds_add_rtn_u32 v67, v67, v2 offset:16
    s_waitcnt lgkmcnt(8)
    s_waitcnt vmcnt(6)
    v_lshl_or_b32 v56, v24, 16, v56
    v_and_or_b32 v57, v24, s31, v57
    v_lshl_or_b32 v58, v25, 16, v58
    v_and_or_b32 v59, v25, s31, v59
    ds_add_rtn_u32 v68, v68, v2 offset:16
    ds_add_rtn_u32 v69, v69, v2 offset:16
    ds_add_rtn_u32 v70, v70, v2 offset:16
    ds_add_rtn_u32 v71, v71, v2 offset:16
    s_waitcnt lgkmcnt(8)
    s_waitcnt vmcnt(5)
    v_lshl_or_b32 v60, v26, 16, v60
    v_and_or_b32 v61, v26, s31, v61
    v_lshl_or_b32 v62, v27, 16, v62
    v_and_or_b32 v63, v27, s31, v63
    ds_add_rtn_u32 v72, v72, v2 offset:16
    ds_add_rtn_u32 v73, v73, v2 offset:16
    ds_add_rtn_u32 v74, v74, v2 offset:16
    ds_add_rtn_u32 v75, v75, v2 offset:16
    s_waitcnt lgkmcnt(8)
    s_waitcnt vmcnt(3)
    v_lshl_or_b32 v64, v12, 16, v64
    v_and_or_b32 v65, v12, s31, v65
    v_lshl_or_b32 v66, v13, 16, v66
    v_and_or_b32 v67, v13, s31, v67
    ds_add_rtn_u32 v76, v76, v2 offset:16
    ds_add_rtn_u32 v77, v77, v2 offset:16
    ds_add_rtn_u32 v78, v78, v2 offset:16
    ds_add_rtn_u32 v79, v79, v2 offset:16
    s_waitcnt lgkmcnt(8)
    s_waitcnt vmcnt(2)
    v_lshl_or_b32 v68, v14, 16, v68
    v_and_or_b32 v69, v14, s31, v69
    v_lshl_or_b32 v70, v15, 16, v70
    v_and_or_b32 v71, v15, s31, v71
    s_waitcnt lgkmcnt(4)
    s_waitcnt vmcnt(1)
    v_lshl_or_b32 v72, v16, 16, v72
    v_and_or_b32 v73, v16, s31, v73
    v_lshl_or_b32 v74, v17, 16, v74
    v_and_or_b32 v75, v17, s31, v75
    s_waitcnt lgkmcnt(0)
    s_waitcnt vmcnt(0)
    v_lshl_or_b32 v76, v18, 16, v76
    v_and_or_b32 v77, v18, s31, v77
    v_lshl_or_b32 v78, v19, 16, v78
    v_and_or_b32 v79, v19, s31, v79
    s_waitcnt vmcnt(4)
    v_cmp_gt_u32 vcc, 848, v0
    s_and_saveexec_b64 s[40:41], vcc
    s_cbranch_execz P1_rk
    ds_add_rtn_u32 v29, v29, v2 offset:16
    s_waitcnt lgkmcnt(0)
    v_lshl_or_b32 v29, v28, 16, v29
P1_rk:
    s_mov_b64 exec, s[40:41]
    s_waitcnt lgkmcnt(0)
    s_barrier
    s_mov_b32 s80, s70
    s_and_b32 s81, s71, 0xffff
    s_mov_b32 s82, 25600000
    s_mov_b32 s83, 0x20000
    v_cmp_gt_u32 vcc, 782, v0
    v_lshlrev_b32 v28, 7, v0
    s_mul_i32 s36, s2, 100096
    v_cndmask_b32 v28, v3, v28, vcc
    buffer_load_dword v31, v28, s[80:83], s36 offen
    s_mov_b32 s37, 12
    v_and_b32 v12, 3, v0
    v_lshlrev_b32 v12, 12, v12
    v_and_b32 v13, 0x3fc, v0
    v_add3_u32 v12, v12, v13, s37
    ds_read2_b32 v[4:5], v12 offset0:0 offset1:1
    v_add_u32 v12, 1024, v12
    ds_read2_b32 v[6:7], v12 offset0:0 offset1:1
    v_add_u32 v12, 1024, v12
    ds_read2_b32 v[8:9], v12 offset0:0 offset1:1
    v_add_u32 v12, 1024, v12
    ds_read2_b32 v[10:11], v12 offset0:0 offset1:1
    s_waitcnt lgkmcnt(0)
    s_barrier
    v_sub_u32 v5, v5, v4
    v_lshl_or_b32 v12, v5, 16, v4
    v_sub_u32 v7, v7, v6
    v_lshl_or_b32 v13, v7, 16, v6
    v_sub_u32 v9, v9, v8
    v_lshl_or_b32 v14, v9, 16, v8
    v_sub_u32 v11, v11, v10
    v_lshl_or_b32 v15, v11, 16, v10
    s_lshl_b32 s36, s2, 14
    s_mul_i32 s47, s2, 300032
    buffer_store_dwordx4 v[12:15], v1, s[24:27], s36 offen sc1
    v_mov_b32 v2, 6
    v_mul_u32_u24_sdwa v8, v32, v2 dst_sel:DWORD dst_unused:UNUSED_PAD src0_sel:WORD_0 src1_sel:DWORD
    v_and_b32 v9, 2, v8
    v_add_u32 v10, v8, v9
    v_mad_i32_i24 v8, v9, -2, v8
    ds_write_b32 v10, v80
    ds_write_b16_d16_hi v8, v32 offset:4
    v_mul_u32_u24_sdwa v11, v33, v2 dst_sel:DWORD dst_unused:UNUSED_PAD src0_sel:WORD_0 src1_sel:DWORD
    v_and_b32 v6, 2, v11
    v_add_u32 v7, v11, v6
    v_mad_i32_i24 v11, v6, -2, v11
    ds_write_b32 v7, v81
    ds_write_b16_d16_hi v11, v33 offset:4
    v_mul_u32_u24_sdwa v8, v34, v2 dst_sel:DWORD dst_unused:UNUSED_PAD src0_sel:WORD_0 src1_sel:DWORD
    v_and_b32 v9, 2, v8
    v_add_u32 v10, v8, v9
    v_mad_i32_i24 v8, v9, -2, v8
    ds_write_b32 v10, v82
    ds_write_b16_d16_hi v8, v34 offset:4
    v_mul_u32_u24_sdwa v11, v35, v2 dst_sel:DWORD dst_unused:UNUSED_PAD src0_sel:WORD_0 src1_sel:DWORD
    v_and_b32 v6, 2, v11
    v_add_u32 v7, v11, v6
    v_mad_i32_i24 v11, v6, -2, v11
    ds_write_b32 v7, v83
    ds_write_b16_d16_hi v11, v35 offset:4
    v_mul_u32_u24_sdwa v8, v36, v2 dst_sel:DWORD dst_unused:UNUSED_PAD src0_sel:WORD_0 src1_sel:DWORD
    v_and_b32 v9, 2, v8
    v_add_u32 v10, v8, v9
    v_mad_i32_i24 v8, v9, -2, v8
    ds_write_b32 v10, v84
    ds_write_b16_d16_hi v8, v36 offset:4
    v_mul_u32_u24_sdwa v11, v37, v2 dst_sel:DWORD dst_unused:UNUSED_PAD src0_sel:WORD_0 src1_sel:DWORD
    v_and_b32 v6, 2, v11
    v_add_u32 v7, v11, v6
    v_mad_i32_i24 v11, v6, -2, v11
    ds_write_b32 v7, v85
    ds_write_b16_d16_hi v11, v37 offset:4
    v_mul_u32_u24_sdwa v8, v38, v2 dst_sel:DWORD dst_unused:UNUSED_PAD src0_sel:WORD_0 src1_sel:DWORD
    v_and_b32 v9, 2, v8
    v_add_u32 v10, v8, v9
    v_mad_i32_i24 v8, v9, -2, v8
    ds_write_b32 v10, v86
    ds_write_b16_d16_hi v8, v38 offset:4
    v_mul_u32_u24_sdwa v11, v39, v2 dst_sel:DWORD dst_unused:UNUSED_PAD src0_sel:WORD_0 src1_sel:DWORD
    v_and_b32 v6, 2, v11
    v_add_u32 v7, v11, v6
    v_mad_i32_i24 v11, v6, -2, v11
    ds_write_b32 v7, v87
    ds_write_b16_d16_hi v11, v39 offset:4
    v_mul_u32_u24_sdwa v8, v40, v2 dst_sel:DWORD dst_unused:UNUSED_PAD src0_sel:WORD_0 src1_sel:DWORD
    v_and_b32 v9, 2, v8
    v_add_u32 v10, v8, v9
    v_mad_i32_i24 v8, v9, -2, v8
    ds_write_b32 v10, v88
    ds_write_b16_d16_hi v8, v40 offset:4
    v_mul_u32_u24_sdwa v11, v41, v2 dst_sel:DWORD dst_unused:UNUSED_PAD src0_sel:WORD_0 src1_sel:DWORD
    v_and_b32 v6, 2, v11
    v_add_u32 v7, v11, v6
    v_mad_i32_i24 v11, v6, -2, v11
    ds_write_b32 v7, v89
    ds_write_b16_d16_hi v11, v41 offset:4
    v_mul_u32_u24_sdwa v8, v42, v2 dst_sel:DWORD dst_unused:UNUSED_PAD src0_sel:WORD_0 src1_sel:DWORD
    v_and_b32 v9, 2, v8
    v_add_u32 v10, v8, v9
    v_mad_i32_i24 v8, v9, -2, v8
    ds_write_b32 v10, v90
    ds_write_b16_d16_hi v8, v42 offset:4
    v_mul_u32_u24_sdwa v11, v43, v2 dst_sel:DWORD dst_unused:UNUSED_PAD src0_sel:WORD_0 src1_sel:DWORD
    v_and_b32 v6, 2, v11
    v_add_u32 v7, v11, v6
    v_mad_i32_i24 v11, v6, -2, v11
    ds_write_b32 v7, v91
    ds_write_b16_d16_hi v11, v43 offset:4
    v_mul_u32_u24_sdwa v8, v44, v2 dst_sel:DWORD dst_unused:UNUSED_PAD src0_sel:WORD_0 src1_sel:DWORD
    v_and_b32 v9, 2, v8
    v_add_u32 v10, v8, v9
    v_mad_i32_i24 v8, v9, -2, v8
    ds_write_b32 v10, v92
    ds_write_b16_d16_hi v8, v44 offset:4
    v_mul_u32_u24_sdwa v11, v45, v2 dst_sel:DWORD dst_unused:UNUSED_PAD src0_sel:WORD_0 src1_sel:DWORD
    v_and_b32 v6, 2, v11
    v_add_u32 v7, v11, v6
    v_mad_i32_i24 v11, v6, -2, v11
    ds_write_b32 v7, v93
    ds_write_b16_d16_hi v11, v45 offset:4
    v_mul_u32_u24_sdwa v8, v46, v2 dst_sel:DWORD dst_unused:UNUSED_PAD src0_sel:WORD_0 src1_sel:DWORD
    v_and_b32 v9, 2, v8
    v_add_u32 v10, v8, v9
    v_mad_i32_i24 v8, v9, -2, v8
    ds_write_b32 v10, v94
    ds_write_b16_d16_hi v8, v46 offset:4
    v_mul_u32_u24_sdwa v11, v47, v2 dst_sel:DWORD dst_unused:UNUSED_PAD src0_sel:WORD_0 src1_sel:DWORD
    v_and_b32 v6, 2, v11
    v_add_u32 v7, v11, v6
    v_mad_i32_i24 v11, v6, -2, v11
    ds_write_b32 v7, v95
    ds_write_b16_d16_hi v11, v47 offset:4
    v_mul_u32_u24_sdwa v8, v48, v2 dst_sel:DWORD dst_unused:UNUSED_PAD src0_sel:WORD_0 src1_sel:DWORD
    v_and_b32 v9, 2, v8
    v_add_u32 v10, v8, v9
    v_mad_i32_i24 v8, v9, -2, v8
    ds_write_b32 v10, v96
    ds_write_b16_d16_hi v8, v48 offset:4
    v_mul_u32_u24_sdwa v11, v49, v2 dst_sel:DWORD dst_unused:UNUSED_PAD src0_sel:WORD_0 src1_sel:DWORD
    v_and_b32 v6, 2, v11
    v_add_u32 v7, v11, v6
    v_mad_i32_i24 v11, v6, -2, v11
    ds_write_b32 v7, v97
    ds_write_b16_d16_hi v11, v49 offset:4
    v_mul_u32_u24_sdwa v8, v50, v2 dst_sel:DWORD dst_unused:UNUSED_PAD src0_sel:WORD_0 src1_sel:DWORD
    v_and_b32 v9, 2, v8
    v_add_u32 v10, v8, v9
    v_mad_i32_i24 v8, v9, -2, v8
    ds_write_b32 v10, v98
    ds_write_b16_d16_hi v8, v50 offset:4
    v_mul_u32_u24_sdwa v11, v51, v2 dst_sel:DWORD dst_unused:UNUSED_PAD src0_sel:WORD_0 src1_sel:DWORD
    v_and_b32 v6, 2, v11
    v_add_u32 v7, v11, v6
    v_mad_i32_i24 v11, v6, -2, v11
    ds_write_b32 v7, v99
    ds_write_b16_d16_hi v11, v51 offset:4
    v_mul_u32_u24_sdwa v8, v52, v2 dst_sel:DWORD dst_unused:UNUSED_PAD src0_sel:WORD_0 src1_sel:DWORD
    v_and_b32 v9, 2, v8
    v_add_u32 v10, v8, v9
    v_mad_i32_i24 v8, v9, -2, v8
    ds_write_b32 v10, v100
    ds_write_b16_d16_hi v8, v52 offset:4
    v_mul_u32_u24_sdwa v11, v53, v2 dst_sel:DWORD dst_unused:UNUSED_PAD src0_sel:WORD_0 src1_sel:DWORD
    v_and_b32 v6, 2, v11
    v_add_u32 v7, v11, v6
    v_mad_i32_i24 v11, v6, -2, v11
    ds_write_b32 v7, v101
    ds_write_b16_d16_hi v11, v53 offset:4
    v_mul_u32_u24_sdwa v8, v54, v2 dst_sel:DWORD dst_unused:UNUSED_PAD src0_sel:WORD_0 src1_sel:DWORD
    v_and_b32 v9, 2, v8
    v_add_u32 v10, v8, v9
    v_mad_i32_i24 v8, v9, -2, v8
    ds_write_b32 v10, v102
    ds_write_b16_d16_hi v8, v54 offset:4
    v_mul_u32_u24_sdwa v11, v55, v2 dst_sel:DWORD dst_unused:UNUSED_PAD src0_sel:WORD_0 src1_sel:DWORD
    v_and_b32 v6, 2, v11
    v_add_u32 v7, v11, v6
    v_mad_i32_i24 v11, v6, -2, v11
    ds_write_b32 v7, v103
    ds_write_b16_d16_hi v11, v55 offset:4
    v_mul_u32_u24_sdwa v8, v56, v2 dst_sel:DWORD dst_unused:UNUSED_PAD src0_sel:WORD_0 src1_sel:DWORD
    v_and_b32 v9, 2, v8
    v_add_u32 v10, v8, v9
    v_mad_i32_i24 v8, v9, -2, v8
    ds_write_b32 v10, v104
    ds_write_b16_d16_hi v8, v56 offset:4
    v_mul_u32_u24_sdwa v11, v57, v2 dst_sel:DWORD dst_unused:UNUSED_PAD src0_sel:WORD_0 src1_sel:DWORD
    v_and_b32 v6, 2, v11
    v_add_u32 v7, v11, v6
    v_mad_i32_i24 v11, v6, -2, v11
    ds_write_b32 v7, v105
    ds_write_b16_d16_hi v11, v57 offset:4
    v_mul_u32_u24_sdwa v8, v58, v2 dst_sel:DWORD dst_unused:UNUSED_PAD src0_sel:WORD_0 src1_sel:DWORD
    v_and_b32 v9, 2, v8
    v_add_u32 v10, v8, v9
    v_mad_i32_i24 v8, v9, -2, v8
    ds_write_b32 v10, v106
    ds_write_b16_d16_hi v8, v58 offset:4
    v_mul_u32_u24_sdwa v11, v59, v2 dst_sel:DWORD dst_unused:UNUSED_PAD src0_sel:WORD_0 src1_sel:DWORD
    v_and_b32 v6, 2, v11
    v_add_u32 v7, v11, v6
    v_mad_i32_i24 v11, v6, -2, v11
    ds_write_b32 v7, v107
    ds_write_b16_d16_hi v11, v59 offset:4
    v_mul_u32_u24_sdwa v8, v60, v2 dst_sel:DWORD dst_unused:UNUSED_PAD src0_sel:WORD_0 src1_sel:DWORD
    v_and_b32 v9, 2, v8
    v_add_u32 v10, v8, v9
    v_mad_i32_i24 v8, v9, -2, v8
    ds_write_b32 v10, v108
    ds_write_b16_d16_hi v8, v60 offset:4
    v_mul_u32_u24_sdwa v11, v61, v2 dst_sel:DWORD dst_unused:UNUSED_PAD src0_sel:WORD_0 src1_sel:DWORD
    v_and_b32 v6, 2, v11
    v_add_u32 v7, v11, v6
    v_mad_i32_i24 v11, v6, -2, v11
    ds_write_b32 v7, v109
    ds_write_b16_d16_hi v11, v61 offset:4
    v_mul_u32_u24_sdwa v8, v62, v2 dst_sel:DWORD dst_unused:UNUSED_PAD src0_sel:WORD_0 src1_sel:DWORD
    v_and_b32 v9, 2, v8
    v_add_u32 v10, v8, v9
    v_mad_i32_i24 v8, v9, -2, v8
    ds_write_b32 v10, v110
    ds_write_b16_d16_hi v8, v62 offset:4
    v_mul_u32_u24_sdwa v11, v63, v2 dst_sel:DWORD dst_unused:UNUSED_PAD src0_sel:WORD_0 src1_sel:DWORD
    v_and_b32 v6, 2, v11
    v_add_u32 v7, v11, v6
    v_mad_i32_i24 v11, v6, -2, v11
    ds_write_b32 v7, v111
    ds_write_b16_d16_hi v11, v63 offset:4
    v_mul_u32_u24_sdwa v8, v64, v2 dst_sel:DWORD dst_unused:UNUSED_PAD src0_sel:WORD_0 src1_sel:DWORD
    v_and_b32 v9, 2, v8
    v_add_u32 v10, v8, v9
    v_mad_i32_i24 v8, v9, -2, v8
    ds_write_b32 v10, v112
    ds_write_b16_d16_hi v8, v64 offset:4
    v_mul_u32_u24_sdwa v11, v65, v2 dst_sel:DWORD dst_unused:UNUSED_PAD src0_sel:WORD_0 src1_sel:DWORD
    v_and_b32 v6, 2, v11
    v_add_u32 v7, v11, v6
    v_mad_i32_i24 v11, v6, -2, v11
    ds_write_b32 v7, v113
    ds_write_b16_d16_hi v11, v65 offset:4
    v_mul_u32_u24_sdwa v8, v66, v2 dst_sel:DWORD dst_unused:UNUSED_PAD src0_sel:WORD_0 src1_sel:DWORD
    v_and_b32 v9, 2, v8
    v_add_u32 v10, v8, v9
    v_mad_i32_i24 v8, v9, -2, v8
    ds_write_b32 v10, v114
    ds_write_b16_d16_hi v8, v66 offset:4
    v_mul_u32_u24_sdwa v11, v67, v2 dst_sel:DWORD dst_unused:UNUSED_PAD src0_sel:WORD_0 src1_sel:DWORD
    v_and_b32 v6, 2, v11
    v_add_u32 v7, v11, v6
    v_mad_i32_i24 v11, v6, -2, v11
    ds_write_b32 v7, v115
    ds_write_b16_d16_hi v11, v67 offset:4
    v_mul_u32_u24_sdwa v8, v68, v2 dst_sel:DWORD dst_unused:UNUSED_PAD src0_sel:WORD_0 src1_sel:DWORD
    v_and_b32 v9, 2, v8
    v_add_u32 v10, v8, v9
    v_mad_i32_i24 v8, v9, -2, v8
    ds_write_b32 v10, v116
    ds_write_b16_d16_hi v8, v68 offset:4
    v_mul_u32_u24_sdwa v11, v69, v2 dst_sel:DWORD dst_unused:UNUSED_PAD src0_sel:WORD_0 src1_sel:DWORD
    v_and_b32 v6, 2, v11
    v_add_u32 v7, v11, v6
    v_mad_i32_i24 v11, v6, -2, v11
    ds_write_b32 v7, v117
    ds_write_b16_d16_hi v11, v69 offset:4
    v_mul_u32_u24_sdwa v8, v70, v2 dst_sel:DWORD dst_unused:UNUSED_PAD src0_sel:WORD_0 src1_sel:DWORD
    v_and_b32 v9, 2, v8
    v_add_u32 v10, v8, v9
    v_mad_i32_i24 v8, v9, -2, v8
    ds_write_b32 v10, v118
    ds_write_b16_d16_hi v8, v70 offset:4
    v_mul_u32_u24_sdwa v11, v71, v2 dst_sel:DWORD dst_unused:UNUSED_PAD src0_sel:WORD_0 src1_sel:DWORD
    v_and_b32 v6, 2, v11
    v_add_u32 v7, v11, v6
    v_mad_i32_i24 v11, v6, -2, v11
    ds_write_b32 v7, v119
    ds_write_b16_d16_hi v11, v71 offset:4
    v_mul_u32_u24_sdwa v8, v72, v2 dst_sel:DWORD dst_unused:UNUSED_PAD src0_sel:WORD_0 src1_sel:DWORD
    v_and_b32 v9, 2, v8
    v_add_u32 v10, v8, v9
    v_mad_i32_i24 v8, v9, -2, v8
    ds_write_b32 v10, v120
    ds_write_b16_d16_hi v8, v72 offset:4
    v_mul_u32_u24_sdwa v11, v73, v2 dst_sel:DWORD dst_unused:UNUSED_PAD src0_sel:WORD_0 src1_sel:DWORD
    v_and_b32 v6, 2, v11
    v_add_u32 v7, v11, v6
    v_mad_i32_i24 v11, v6, -2, v11
    ds_write_b32 v7, v121
    ds_write_b16_d16_hi v11, v73 offset:4
    v_mul_u32_u24_sdwa v8, v74, v2 dst_sel:DWORD dst_unused:UNUSED_PAD src0_sel:WORD_0 src1_sel:DWORD
    v_and_b32 v9, 2, v8
    v_add_u32 v10, v8, v9
    v_mad_i32_i24 v8, v9, -2, v8
    ds_write_b32 v10, v122
    ds_write_b16_d16_hi v8, v74 offset:4
    v_mul_u32_u24_sdwa v11, v75, v2 dst_sel:DWORD dst_unused:UNUSED_PAD src0_sel:WORD_0 src1_sel:DWORD
    v_and_b32 v6, 2, v11
    v_add_u32 v7, v11, v6
    v_mad_i32_i24 v11, v6, -2, v11
    ds_write_b32 v7, v123
    ds_write_b16_d16_hi v11, v75 offset:4
    v_mul_u32_u24_sdwa v8, v76, v2 dst_sel:DWORD dst_unused:UNUSED_PAD src0_sel:WORD_0 src1_sel:DWORD
    v_and_b32 v9, 2, v8
    v_add_u32 v10, v8, v9
    v_mad_i32_i24 v8, v9, -2, v8
    ds_write_b32 v10, v124
    ds_write_b16_d16_hi v8, v76 offset:4
    v_mul_u32_u24_sdwa v11, v77, v2 dst_sel:DWORD dst_unused:UNUSED_PAD src0_sel:WORD_0 src1_sel:DWORD
    v_and_b32 v6, 2, v11
    v_add_u32 v7, v11, v6
    v_mad_i32_i24 v11, v6, -2, v11
    ds_write_b32 v7, v125
    ds_write_b16_d16_hi v11, v77 offset:4
    v_mul_u32_u24_sdwa v8, v78, v2 dst_sel:DWORD dst_unused:UNUSED_PAD src0_sel:WORD_0 src1_sel:DWORD
    v_and_b32 v9, 2, v8
    v_add_u32 v10, v8, v9
    v_mad_i32_i24 v8, v9, -2, v8
    ds_write_b32 v10, v126
    ds_write_b16_d16_hi v8, v78 offset:4
    v_mul_u32_u24_sdwa v11, v79, v2 dst_sel:DWORD dst_unused:UNUSED_PAD src0_sel:WORD_0 src1_sel:DWORD
    v_and_b32 v6, 2, v11
    v_add_u32 v7, v11, v6
    v_mad_i32_i24 v11, v6, -2, v11
    ds_write_b32 v7, v127
    ds_write_b16_d16_hi v11, v79 offset:4
    v_cmp_gt_u32 vcc, 848, v0
    s_and_saveexec_b64 s[40:41], vcc
    s_cbranch_execz P1_sc0
    v_mul_u32_u24_sdwa v8, v29, v2 dst_sel:DWORD dst_unused:UNUSED_PAD src0_sel:WORD_0 src1_sel:DWORD
    v_and_b32 v9, 2, v8
    v_add_u32 v10, v8, v9
    v_mad_i32_i24 v8, v9, -2, v8
    ds_write_b32 v10, v30
    ds_write_b16_d16_hi v8, v29 offset:4
P1_sc0:
    s_mov_b64 exec, s[40:41]
    s_waitcnt lgkmcnt(0)
    s_barrier
    v_add_u32 v8, 0x10000, v1
    v_add_u32 v9, 0x20000, v1
    ds_read_b128 v[12:15], v1 offset:0
    ds_read_b128 v[16:19], v1 offset:16384
    ds_read_b128 v[20:23], v1 offset:32768
    ds_read_b128 v[24:27], v1 offset:49152
    ds_read_b128 v[4:7], v8 offset:0
    s_waitcnt lgkmcnt(4)
    s_add_u32 s36, s47, 0
    buffer_store_dwordx4 v[12:15], v1, s[20:23], s36 offen sc1
    s_waitcnt lgkmcnt(3)
    s_add_u32 s36, s47, 16384
    buffer_store_dwordx4 v[16:19], v1, s[20:23], s36 offen sc1
    s_waitcnt lgkmcnt(2)
    s_add_u32 s36, s47, 32768
    buffer_store_dwordx4 v[20:23], v1, s[20:23], s36 offen sc1
    s_waitcnt lgkmcnt(1)
    s_add_u32 s36, s47, 49152
    buffer_store_dwordx4 v[24:27], v1, s[20:23], s36 offen sc1
    s_waitcnt lgkmcnt(0)
    s_add_u32 s36, s47, 65536
    buffer_store_dwordx4 v[4:7], v1, s[20:23], s36 offen sc1
    ds_read_b128 v[12:15], v8 offset:16384
    ds_read_b128 v[16:19], v8 offset:32768
    ds_read_b128 v[20:23], v8 offset:49152
    ds_read_b128 v[24:27], v9 offset:0
    v_cmp_gt_u32 vcc, 528, v0
    s_and_saveexec_b64 s[40:41], vcc
    ds_read_b128 v[4:7], v9 offset:16384
    s_mov_b64 exec, s[40:41]
    v_cndmask_b32 v9, v3, v1, vcc
    v_mov_b32 v10, 163836
    v_mov_b32 v11, 0
    ds_write_b32 v10, v11
    s_waitcnt lgkmcnt(0)
    s_add_u32 s36, s47, 147456
    buffer_store_dwordx4 v[4:7], v9, s[20:23], s36 offen sc1
    s_barrier
    v_and_b32 v8, 0xffff, v32
    v_mad_u32_u24 v8, v8, 6, s32
    v_and_b32 v9, 2, v8
    v_add_u32 v10, v8, v9
    v_mad_i32_i24 v8, v9, -2, v8
    ds_write_b32 v10, v80
    ds_write_b16_d16_hi v8, v32 offset:4
    v_and_b32 v11, 0xffff, v33
    v_mad_u32_u24 v11, v11, 6, s32
    v_and_b32 v6, 2, v11
    v_add_u32 v7, v11, v6
    v_mad_i32_i24 v11, v6, -2, v11
    ds_write_b32 v7, v81
    ds_write_b16_d16_hi v11, v33 offset:4
    v_and_b32 v8, 0xffff, v34
    v_mad_u32_u24 v8, v8, 6, s32
    v_and_b32 v9, 2, v8
    v_add_u32 v10, v8, v9
    v_mad_i32_i24 v8, v9, -2, v8
    ds_write_b32 v10, v82
    ds_write_b16_d16_hi v8, v34 offset:4
    v_and_b32 v11, 0xffff, v35
    v_mad_u32_u24 v11, v11, 6, s32
    v_and_b32 v6, 2, v11
    v_add_u32 v7, v11, v6
    v_mad_i32_i24 v11, v6, -2, v11
    ds_write_b32 v7, v83
    ds_write_b16_d16_hi v11, v35 offset:4
    s_add_u32 s36, s47, 81920
    buffer_store_dwordx4 v[12:15], v1, s[20:23], s36 offen sc1
    v_and_b32 v8, 0xffff, v36
    v_mad_u32_u24 v8, v8, 6, s32
    v_and_b32 v9, 2, v8
    v_add_u32 v10, v8, v9
    v_mad_i32_i24 v8, v9, -2, v8
    ds_write_b32 v10, v84
    ds_write_b16_d16_hi v8, v36 offset:4
    v_and_b32 v11, 0xffff, v37
    v_mad_u32_u24 v11, v11, 6, s32
    v_and_b32 v6, 2, v11
    v_add_u32 v7, v11, v6
    v_mad_i32_i24 v11, v6, -2, v11
    ds_write_b32 v7, v85
    ds_write_b16_d16_hi v11, v37 offset:4
    v_and_b32 v8, 0xffff, v38
    v_mad_u32_u24 v8, v8, 6, s32
    v_and_b32 v9, 2, v8
    v_add_u32 v10, v8, v9
    v_mad_i32_i24 v8, v9, -2, v8
    ds_write_b32 v10, v86
    ds_write_b16_d16_hi v8, v38 offset:4
    v_and_b32 v11, 0xffff, v39
    v_mad_u32_u24 v11, v11, 6, s32
    v_and_b32 v6, 2, v11
    v_add_u32 v7, v11, v6
    v_mad_i32_i24 v11, v6, -2, v11
    ds_write_b32 v7, v87
    ds_write_b16_d16_hi v11, v39 offset:4
    s_add_u32 s36, s47, 98304
    buffer_store_dwordx4 v[16:19], v1, s[20:23], s36 offen sc1
    v_and_b32 v8, 0xffff, v40
    v_mad_u32_u24 v8, v8, 6, s32
    v_and_b32 v9, 2, v8
    v_add_u32 v10, v8, v9
    v_mad_i32_i24 v8, v9, -2, v8
    ds_write_b32 v10, v88
    ds_write_b16_d16_hi v8, v40 offset:4
    v_and_b32 v11, 0xffff, v41
    v_mad_u32_u24 v11, v11, 6, s32
    v_and_b32 v6, 2, v11
    v_add_u32 v7, v11, v6
    v_mad_i32_i24 v11, v6, -2, v11
    ds_write_b32 v7, v89
    ds_write_b16_d16_hi v11, v41 offset:4
    v_and_b32 v8, 0xffff, v42
    v_mad_u32_u24 v8, v8, 6, s32
    v_and_b32 v9, 2, v8
    v_add_u32 v10, v8, v9
    v_mad_i32_i24 v8, v9, -2, v8
    ds_write_b32 v10, v90
    ds_write_b16_d16_hi v8, v42 offset:4
    v_and_b32 v11, 0xffff, v43
    v_mad_u32_u24 v11, v11, 6, s32
    v_and_b32 v6, 2, v11
    v_add_u32 v7, v11, v6
    v_mad_i32_i24 v11, v6, -2, v11
    ds_write_b32 v7, v91
    ds_write_b16_d16_hi v11, v43 offset:4
    s_add_u32 s36, s47, 114688
    buffer_store_dwordx4 v[20:23], v1, s[20:23], s36 offen sc1
    v_and_b32 v8, 0xffff, v44
    v_mad_u32_u24 v8, v8, 6, s32
    v_and_b32 v9, 2, v8
    v_add_u32 v10, v8, v9
    v_mad_i32_i24 v8, v9, -2, v8
    ds_write_b32 v10, v92
    ds_write_b16_d16_hi v8, v44 offset:4
    v_and_b32 v11, 0xffff, v45
    v_mad_u32_u24 v11, v11, 6, s32
    v_and_b32 v6, 2, v11
    v_add_u32 v7, v11, v6
    v_mad_i32_i24 v11, v6, -2, v11
    ds_write_b32 v7, v93
    ds_write_b16_d16_hi v11, v45 offset:4
    v_and_b32 v8, 0xffff, v46
    v_mad_u32_u24 v8, v8, 6, s32
    v_and_b32 v9, 2, v8
    v_add_u32 v10, v8, v9
    v_mad_i32_i24 v8, v9, -2, v8
    ds_write_b32 v10, v94
    ds_write_b16_d16_hi v8, v46 offset:4
    v_and_b32 v11, 0xffff, v47
    v_mad_u32_u24 v11, v11, 6, s32
    v_and_b32 v6, 2, v11
    v_add_u32 v7, v11, v6
    v_mad_i32_i24 v11, v6, -2, v11
    ds_write_b32 v7, v95
    ds_write_b16_d16_hi v11, v47 offset:4
    s_add_u32 s36, s47, 131072
    buffer_store_dwordx4 v[24:27], v1, s[20:23], s36 offen sc1
    v_and_b32 v8, 0xffff, v48
    v_mad_u32_u24 v8, v8, 6, s32
    v_and_b32 v9, 2, v8
    v_add_u32 v10, v8, v9
    v_mad_i32_i24 v8, v9, -2, v8
    ds_write_b32 v10, v96
    ds_write_b16_d16_hi v8, v48 offset:4
    v_and_b32 v11, 0xffff, v49
    v_mad_u32_u24 v11, v11, 6, s32
    v_and_b32 v6, 2, v11
    v_add_u32 v7, v11, v6
    v_mad_i32_i24 v11, v6, -2, v11
    ds_write_b32 v7, v97
    ds_write_b16_d16_hi v11, v49 offset:4
    v_and_b32 v8, 0xffff, v50
    v_mad_u32_u24 v8, v8, 6, s32
    v_and_b32 v9, 2, v8
    v_add_u32 v10, v8, v9
    v_mad_i32_i24 v8, v9, -2, v8
    ds_write_b32 v10, v98
    ds_write_b16_d16_hi v8, v50 offset:4
    v_and_b32 v11, 0xffff, v51
    v_mad_u32_u24 v11, v11, 6, s32
    v_and_b32 v6, 2, v11
    v_add_u32 v7, v11, v6
    v_mad_i32_i24 v11, v6, -2, v11
    ds_write_b32 v7, v99
    ds_write_b16_d16_hi v11, v51 offset:4
    v_and_b32 v8, 0xffff, v52
    v_mad_u32_u24 v8, v8, 6, s32
    v_and_b32 v9, 2, v8
    v_add_u32 v10, v8, v9
    v_mad_i32_i24 v8, v9, -2, v8
    ds_write_b32 v10, v100
    ds_write_b16_d16_hi v8, v52 offset:4
    v_and_b32 v11, 0xffff, v53
    v_mad_u32_u24 v11, v11, 6, s32
    v_and_b32 v6, 2, v11
    v_add_u32 v7, v11, v6
    v_mad_i32_i24 v11, v6, -2, v11
    ds_write_b32 v7, v101
    ds_write_b16_d16_hi v11, v53 offset:4
    v_and_b32 v8, 0xffff, v54
    v_mad_u32_u24 v8, v8, 6, s32
    v_and_b32 v9, 2, v8
    v_add_u32 v10, v8, v9
    v_mad_i32_i24 v8, v9, -2, v8
    ds_write_b32 v10, v102
    ds_write_b16_d16_hi v8, v54 offset:4
    v_and_b32 v11, 0xffff, v55
    v_mad_u32_u24 v11, v11, 6, s32
    v_and_b32 v6, 2, v11
    v_add_u32 v7, v11, v6
    v_mad_i32_i24 v11, v6, -2, v11
    ds_write_b32 v7, v103
    ds_write_b16_d16_hi v11, v55 offset:4
    v_and_b32 v8, 0xffff, v56
    v_mad_u32_u24 v8, v8, 6, s32
    v_and_b32 v9, 2, v8
    v_add_u32 v10, v8, v9
    v_mad_i32_i24 v8, v9, -2, v8
    ds_write_b32 v10, v104
    ds_write_b16_d16_hi v8, v56 offset:4
    v_and_b32 v11, 0xffff, v57
    v_mad_u32_u24 v11, v11, 6, s32
    v_and_b32 v6, 2, v11
    v_add_u32 v7, v11, v6
    v_mad_i32_i24 v11, v6, -2, v11
    ds_write_b32 v7, v105
    ds_write_b16_d16_hi v11, v57 offset:4
    v_and_b32 v8, 0xffff, v58
    v_mad_u32_u24 v8, v8, 6, s32
    v_and_b32 v9, 2, v8
    v_add_u32 v10, v8, v9
    v_mad_i32_i24 v8, v9, -2, v8
    ds_write_b32 v10, v106
    ds_write_b16_d16_hi v8, v58 offset:4
    v_and_b32 v11, 0xffff, v59
    v_mad_u32_u24 v11, v11, 6, s32
    v_and_b32 v6, 2, v11
    v_add_u32 v7, v11, v6
    v_mad_i32_i24 v11, v6, -2, v11
    ds_write_b32 v7, v107
    ds_write_b16_d16_hi v11, v59 offset:4
    v_and_b32 v8, 0xffff, v60
    v_mad_u32_u24 v8, v8, 6, s32
    v_and_b32 v9, 2, v8
    v_add_u32 v10, v8, v9
    v_mad_i32_i24 v8, v9, -2, v8
    ds_write_b32 v10, v108
    ds_write_b16_d16_hi v8, v60 offset:4
    v_and_b32 v11, 0xffff, v61
    v_mad_u32_u24 v11, v11, 6, s32
    v_and_b32 v6, 2, v11
    v_add_u32 v7, v11, v6
    v_mad_i32_i24 v11, v6, -2, v11
    ds_write_b32 v7, v109
    ds_write_b16_d16_hi v11, v61 offset:4
    v_and_b32 v8, 0xffff, v62
    v_mad_u32_u24 v8, v8, 6, s32
    v_and_b32 v9, 2, v8
    v_add_u32 v10, v8, v9
    v_mad_i32_i24 v8, v9, -2, v8
    ds_write_b32 v10, v110
    ds_write_b16_d16_hi v8, v62 offset:4
    v_and_b32 v11, 0xffff, v63
    v_mad_u32_u24 v11, v11, 6, s32
    v_and_b32 v6, 2, v11
    v_add_u32 v7, v11, v6
    v_mad_i32_i24 v11, v6, -2, v11
    ds_write_b32 v7, v111
    ds_write_b16_d16_hi v11, v63 offset:4
    s_waitcnt vmcnt(0)
    v_mov_b32 v31, 163836
    v_mov_b32 v28, 1
    s_mov_b64 exec, 1
    ds_add_rtn_u32 v31, v31, v28
    s_waitcnt lgkmcnt(0)
    v_readfirstlane_b32 s36, v31
    v_mov_b32 v31, 0
    s_cmp_eq_u32 s36, 15
    s_cbranch_scc0 P1_nosig
    global_atomic_add v31, v28, s[86:87] sc1
P1_nosig:
    s_mov_b64 exec, -1
    v_and_b32 v8, 0xffff, v64
    v_mad_u32_u24 v8, v8, 6, s32
    v_and_b32 v9, 2, v8
    v_add_u32 v10, v8, v9
    v_mad_i32_i24 v8, v9, -2, v8
    ds_write_b32 v10, v112
    ds_write_b16_d16_hi v8, v64 offset:4
    v_and_b32 v11, 0xffff, v65
    v_mad_u32_u24 v11, v11, 6, s32
    v_and_b32 v6, 2, v11
    v_add_u32 v7, v11, v6
    v_mad_i32_i24 v11, v6, -2, v11
    ds_write_b32 v7, v113
    ds_write_b16_d16_hi v11, v65 offset:4
    v_and_b32 v8, 0xffff, v66
    v_mad_u32_u24 v8, v8, 6, s32
    v_and_b32 v9, 2, v8
    v_add_u32 v10, v8, v9
    v_mad_i32_i24 v8, v9, -2, v8
    ds_write_b32 v10, v114
    ds_write_b16_d16_hi v8, v66 offset:4
    v_and_b32 v11, 0xffff, v67
    v_mad_u32_u24 v11, v11, 6, s32
    v_and_b32 v6, 2, v11
    v_add_u32 v7, v11, v6
    v_mad_i32_i24 v11, v6, -2, v11
    ds_write_b32 v7, v115
    ds_write_b16_d16_hi v11, v67 offset:4
    v_and_b32 v8, 0xffff, v68
    v_mad_u32_u24 v8, v8, 6, s32
    v_and_b32 v9, 2, v8
    v_add_u32 v10, v8, v9
    v_mad_i32_i24 v8, v9, -2, v8
    ds_write_b32 v10, v116
    ds_write_b16_d16_hi v8, v68 offset:4
    v_and_b32 v11, 0xffff, v69
    v_mad_u32_u24 v11, v11, 6, s32
    v_and_b32 v6, 2, v11
    v_add_u32 v7, v11, v6
    v_mad_i32_i24 v11, v6, -2, v11
    ds_write_b32 v7, v117
    ds_write_b16_d16_hi v11, v69 offset:4
    v_and_b32 v8, 0xffff, v70
    v_mad_u32_u24 v8, v8, 6, s32
    v_and_b32 v9, 2, v8
    v_add_u32 v10, v8, v9
    v_mad_i32_i24 v8, v9, -2, v8
    ds_write_b32 v10, v118
    ds_write_b16_d16_hi v8, v70 offset:4
    v_and_b32 v11, 0xffff, v71
    v_mad_u32_u24 v11, v11, 6, s32
    v_and_b32 v6, 2, v11
    v_add_u32 v7, v11, v6
    v_mad_i32_i24 v11, v6, -2, v11
    ds_write_b32 v7, v119
    ds_write_b16_d16_hi v11, v71 offset:4
    v_and_b32 v8, 0xffff, v72
    v_mad_u32_u24 v8, v8, 6, s32
    v_and_b32 v9, 2, v8
    v_add_u32 v10, v8, v9
    v_mad_i32_i24 v8, v9, -2, v8
    ds_write_b32 v10, v120
    ds_write_b16_d16_hi v8, v72 offset:4
    v_and_b32 v11, 0xffff, v73
    v_mad_u32_u24 v11, v11, 6, s32
    v_and_b32 v6, 2, v11
    v_add_u32 v7, v11, v6
    v_mad_i32_i24 v11, v6, -2, v11
    ds_write_b32 v7, v121
    ds_write_b16_d16_hi v11, v73 offset:4
    v_and_b32 v8, 0xffff, v74
    v_mad_u32_u24 v8, v8, 6, s32
    v_and_b32 v9, 2, v8
    v_add_u32 v10, v8, v9
    v_mad_i32_i24 v8, v9, -2, v8
    ds_write_b32 v10, v122
    ds_write_b16_d16_hi v8, v74 offset:4
    v_and_b32 v11, 0xffff, v75
    v_mad_u32_u24 v11, v11, 6, s32
    v_and_b32 v6, 2, v11
    v_add_u32 v7, v11, v6
    v_mad_i32_i24 v11, v6, -2, v11
    ds_write_b32 v7, v123
    ds_write_b16_d16_hi v11, v75 offset:4
    v_and_b32 v8, 0xffff, v76
    v_mad_u32_u24 v8, v8, 6, s32
    v_and_b32 v9, 2, v8
    v_add_u32 v10, v8, v9
    v_mad_i32_i24 v8, v9, -2, v8
    ds_write_b32 v10, v124
    ds_write_b16_d16_hi v8, v76 offset:4
    v_and_b32 v11, 0xffff, v77
    v_mad_u32_u24 v11, v11, 6, s32
    v_and_b32 v6, 2, v11
    v_add_u32 v7, v11, v6
    v_mad_i32_i24 v11, v6, -2, v11
    ds_write_b32 v7, v125
    ds_write_b16_d16_hi v11, v77 offset:4
    v_and_b32 v8, 0xffff, v78
    v_mad_u32_u24 v8, v8, 6, s32
    v_and_b32 v9, 2, v8
    v_add_u32 v10, v8, v9
    v_mad_i32_i24 v8, v9, -2, v8
    ds_write_b32 v10, v126
    ds_write_b16_d16_hi v8, v78 offset:4
    v_and_b32 v11, 0xffff, v79
    v_mad_u32_u24 v11, v11, 6, s32
    v_and_b32 v6, 2, v11
    v_add_u32 v7, v11, v6
    v_mad_i32_i24 v11, v6, -2, v11
    ds_write_b32 v7, v127
    ds_write_b16_d16_hi v11, v79 offset:4
    v_cmp_gt_u32 vcc, 848, v0
    s_and_saveexec_b64 s[40:41], vcc
    s_cbranch_execz P1_sc1
    v_and_b32 v8, 0xffff, v29
    v_mad_u32_u24 v8, v8, 6, s32
    v_and_b32 v9, 2, v8
    v_add_u32 v10, v8, v9
    v_mad_i32_i24 v8, v9, -2, v8
    ds_write_b32 v10, v30
    ds_write_b16_d16_hi v8, v29 offset:4
P1_sc1:
    s_mov_b64 exec, s[40:41]
    s_waitcnt lgkmcnt(0)
    s_barrier
    v_add_u32 v8, 0x10000, v1
    v_add_u32 v9, 0x20000, v1
    ds_read_b128 v[32:35], v1 offset:0
    ds_read_b128 v[36:39], v1 offset:16384
    ds_read_b128 v[40:43], v1 offset:32768
    ds_read_b128 v[44:47], v1 offset:49152
    ds_read_b128 v[48:51], v8 offset:0
    ds_read_b128 v[52:55], v8 offset:16384
    ds_read_b128 v[56:59], v8 offset:32768
    ds_read_b128 v[60:63], v8 offset:49152
    v_cmp_gt_u32 vcc, 814, v0
    s_and_saveexec_b64 s[40:41], vcc
    ds_read_b128 v[64:67], v9 offset:0
    s_mov_b64 exec, s[40:41]
    v_cndmask_b32 v9, v3, v1, vcc
    s_waitcnt lgkmcnt(7)
    s_add_u32 s36, s47, 155904
    buffer_store_dwordx4 v[32:35], v1, s[20:23], s36 offen sc1
    s_waitcnt lgkmcnt(6)
    s_add_u32 s36, s47, 172288
    buffer_store_dwordx4 v[36:39], v1, s[20:23], s36 offen sc1
    s_waitcnt lgkmcnt(5)
    s_add_u32 s36, s47, 188672
    buffer_store_dwordx4 v[40:43], v1, s[20:23], s36 offen sc1
    s_waitcnt lgkmcnt(4)
    s_add_u32 s36, s47, 205056
    buffer_store_dwordx4 v[44:47], v1, s[20:23], s36 offen sc1
    s_waitcnt lgkmcnt(3)
    s_add_u32 s36, s47, 221440
    buffer_store_dwordx4 v[48:51], v1, s[20:23], s36 offen sc1
    s_waitcnt lgkmcnt(2)
    s_add_u32 s36, s47, 237824
    buffer_store_dwordx4 v[52:55], v1, s[20:23], s36 offen sc1
    s_waitcnt lgkmcnt(1)
    s_add_u32 s36, s47, 254208
    buffer_store_dwordx4 v[56:59], v1, s[20:23], s36 offen sc1
    s_waitcnt lgkmcnt(0)
    s_add_u32 s36, s47, 270592
    buffer_store_dwordx4 v[60:63], v1, s[20:23], s36 offen sc1
    s_waitcnt lgkmcnt(0)
    s_add_u32 s36, s47, 286976
    buffer_store_dwordx4 v[64:67], v9, s[20:23], s36 offen sc1
    s_barrier
P2_entry:
    s_load_dwordx2 s[60:61], s[0:1], 0
    s_load_dwordx2 s[62:63], s[0:1], 24
    s_load_dwordx4 s[64:67], s[0:1], 40
    s_load_dwordx2 s[4:5], s[0:1], 88
    s_load_dwordx2 s[6:7], s[0:1], 104
    s_and_b32 s24, s2, 7
    s_lshl_b32 s24, s24, 5
    s_lshr_b32 s33, s2, 3
    s_add_u32 s24, s24, s33
    v_lshrrev_b32 v117, 6, v0
    v_and_b32 v1, 63, v0
    s_mov_b32 s77, 0xffff0000
    v_readfirstlane_b32 s25, v117
    v_mov_b32 v115, 0x7fffff00
    s_mov_b32 s92, 0x55555555
    s_mov_b32 s93, 0x55555555
    s_waitcnt lgkmcnt(0)
    s_load_dwordx4 s[84:87], s[64:65], 0
    s_load_dword s35, s[66:67], 0
    s_mov_b32 s8, s6
    s_and_b32 s9, s7, 0xffff
    s_mov_b32 s10, 76808192
    s_mov_b32 s11, 0x20000
    s_mov_b32 s12, s60
    s_and_b32 s13, s61, 0xffff
    s_mov_b32 s14, 25600000
    s_mov_b32 s15, 0x20000
    s_mov_b32 s20, s4
    s_and_b32 s21, s5, 0xffff
    s_mov_b32 s22, 25600000
    s_mov_b32 s23, 0x20000
    s_add_u32 s6, s6, 76808192
    s_addc_u32 s7, s7, 0
    s_mov_b32 s16, s6
    s_and_b32 s17, s7, 0xffff
    s_mov_b32 s18, 4202496
    s_mov_b32 s19, 0x20000
    s_mov_b32 s68, s62
    s_and_b32 s69, s63, 0xffff
    s_mov_b32 s70, 1600000
    s_mov_b32 s71, 0x20000
    s_mul_i32 s33, s24, 6250
    v_lshlrev_b32 v119, 1, v0
    buffer_load_ushort v121, v119, s[68:71], s33 offen
    buffer_load_ushort v122, v119, s[68:71], s33 offen offset:2048
    s_add_u32 s33, s33, 4096
    buffer_load_ushort v123, v119, s[68:71], s33 offen
    buffer_load_ushort v124, v119, s[68:71], s33 offen offset:2048
    s_load_dwordx2 s[62:63], s[0:1], 96
    s_mov_b32 s82, 0
    v_mov_b32 v26, 0
    v_mov_b32 v27, 0
    v_mov_b32 v28, 0
    v_mov_b32 v29, 0
    v_lshlrev_b32 v119, 4, v0
    v_add_u32 v126, 50800, v119
    ds_write_b128 v126, v[26:29] offset:0
    ds_write_b128 v126, v[26:29] offset:16384
    ds_write_b128 v126, v[26:29] offset:32768
    ds_write_b128 v126, v[26:29] offset:49152
    v_add_u32 v126, 0x10000, v126
    ds_write_b128 v126, v[26:29] offset:0
    ds_write_b128 v126, v[26:29] offset:16384
    v_cmp_gt_u32 vcc, 106, v0
    s_and_saveexec_b64 s[52:53], vcc
    ds_write_b128 v126, v[26:29] offset:32768
    s_mov_b64 exec, s[52:53]
    v_cmp_gt_u32 vcc, 50, v0
    s_and_saveexec_b64 s[52:53], vcc
    ds_write_b128 v119, v[26:29]
    s_mov_b64 exec, s[52:53]
    s_waitcnt lgkmcnt(0)
    s_and_b32 s91, s87, 0xffff0000
    s_lshl_b32 s90, s87, 16
    s_and_b32 s89, s86, 0xffff0000
    s_lshl_b32 s88, s86, 16
    s_and_b32 s87, s85, 0xffff0000
    s_lshl_b32 s86, s85, 16
    s_and_b32 s85, s84, 0xffff0000
    s_lshl_b32 s84, s84, 16
    s_lshl_b32 s33, s35, 16
    s_and_b32 s34, s35, 0xffff0000
    v_mov_b32 v125, 0.15915494
    v_mul_f32 v126, s33, v125
    v_mul_f32 v125, s34, v125
    v_and_b32 v114, 1, v1
    v_lshlrev_b32 v114, 4, v114
    v_readfirstlane_b32 s79, v126
    v_readfirstlane_b32 s80, v125
    v_and_b32 v125, 15, v1
    v_lshrrev_b32 v126, 4, v1
    v_lshlrev_b32 v112, 1, v125
    v_lshlrev_b32 v110, 2, v126
    v_mul_u32_u24 v126, 300032, v126
    v_mad_u32_u24 v111, v125, 12, v126
    s_mul_i32 s54, s25, 4800512
    s_mul_i32 s76, s25, 808
    s_add_u32 s76, s76, 150800
    s_mov_b32 s27, s76
    s_mov_b32 s26, 0
    s_mov_b64 s[28:29], 0
    s_mov_b64 s[30:31], 0
    s_mov_b32 s58, 0
    s_mov_b32 s59, 0
    s_mov_b32 s78, 100000
    s_mov_b32 s97, 24
    s_mov_b64 s[98:99], 0
    s_mov_b64 s[100:101], 0
    s_and_b32 s3, s2, 0
    s_lshl_b32 s3, s3, 0
    s_mov_b32 s83, -16
    s_waitcnt vmcnt(0)
    v_mov_b32 v119, 163836
    v_mov_b32 v120, 1
    s_mov_b64 exec, 1
    ds_add_rtn_u32 v119, v119, v120
    s_waitcnt lgkmcnt(0)
    v_readfirstlane_b32 s33, v119
    v_mov_b32 v119, 0
    s_cmp_eq_u32 s33, 31
    s_cbranch_scc0 P2_nosig
    global_atomic_add v119, v120, s[62:63] offset:128 sc1
P2_nosig:
    s_mov_b64 exec, -1
    s_mov_b32 s44, 0xc1200000
    s_mov_b32 s45, 0xc166d4ca
    v_lshlrev_b32 v125, 4, v0
    v_lshlrev_b32 v121, 16, v121
    v_subrev_f32 v26, s84, v121
    v_subrev_f32 v27, s85, v121
    v_subrev_f32 v28, s86, v121
    v_subrev_f32 v29, s87, v121
    v_subrev_f32 v30, s88, v121
    v_subrev_f32 v31, s89, v121
    v_subrev_f32 v32, s90, v121
    v_subrev_f32 v33, s91, v121
    v_mul_f32 v26, v26, v26
    v_mul_f32 v27, v27, v27
    v_mul_f32 v28, v28, v28
    v_mul_f32 v29, v29, v29
    v_mul_f32 v30, v30, v30
    v_mul_f32 v31, v31, v31
    v_mul_f32 v32, v32, v32
    v_mul_f32 v33, v33, v33
    v_mul_f32 v26, s45, v26
    v_mul_f32 v27, s45, v27
    v_mul_f32 v28, s45, v28
    v_mul_f32 v29, s45, v29
    v_mul_f32 v30, s45, v30
    v_mul_f32 v31, s45, v31
    v_mul_f32 v32, s45, v32
    v_mul_f32 v33, s45, v33
    v_exp_f32 v26, v26
    v_exp_f32 v27, v27
    v_exp_f32 v28, v28
    v_exp_f32 v29, v29
    v_exp_f32 v30, v30
    v_exp_f32 v31, v31
    v_exp_f32 v32, v32
    v_exp_f32 v33, v33
    s_nop 0
    v_cvt_pk_f16_f32 v34, v26, v27
    v_cvt_pk_f16_f32 v35, v28, v29
    v_cvt_pk_f16_f32 v36, v30, v31
    v_cvt_pk_f16_f32 v37, v32, v33
    ds_write_b128 v125, v[34:37] offset:800
    v_lshlrev_b32 v122, 16, v122
    v_subrev_f32 v26, s84, v122
    v_subrev_f32 v27, s85, v122
    v_subrev_f32 v28, s86, v122
    v_subrev_f32 v29, s87, v122
    v_subrev_f32 v30, s88, v122
    v_subrev_f32 v31, s89, v122
    v_subrev_f32 v32, s90, v122
    v_subrev_f32 v33, s91, v122
    v_mul_f32 v26, v26, v26
    v_mul_f32 v27, v27, v27
    v_mul_f32 v28, v28, v28
    v_mul_f32 v29, v29, v29
    v_mul_f32 v30, v30, v30
    v_mul_f32 v31, v31, v31
    v_mul_f32 v32, v32, v32
    v_mul_f32 v33, v33, v33
    v_mul_f32 v26, s45, v26
    v_mul_f32 v27, s45, v27
    v_mul_f32 v28, s45, v28
    v_mul_f32 v29, s45, v29
    v_mul_f32 v30, s45, v30
    v_mul_f32 v31, s45, v31
    v_mul_f32 v32, s45, v32
    v_mul_f32 v33, s45, v33
    v_exp_f32 v26, v26
    v_exp_f32 v27, v27
    v_exp_f32 v28, v28
    v_exp_f32 v29, v29
    v_exp_f32 v30, v30
    v_exp_f32 v31, v31
    v_exp_f32 v32, v32
    v_exp_f32 v33, v33
    s_nop 0
    v_cvt_pk_f16_f32 v34, v26, v27
    v_cvt_pk_f16_f32 v35, v28, v29
    v_cvt_pk_f16_f32 v36, v30, v31
    v_cvt_pk_f16_f32 v37, v32, v33
    ds_write_b128 v125, v[34:37] offset:17184
    v_lshlrev_b32 v123, 16, v123
    v_subrev_f32 v26, s84, v123
    v_subrev_f32 v27, s85, v123
    v_subrev_f32 v28, s86, v123
    v_subrev_f32 v29, s87, v123
    v_subrev_f32 v30, s88, v123
    v_subrev_f32 v31, s89, v123
    v_subrev_f32 v32, s90, v123
    v_subrev_f32 v33, s91, v123
    v_mul_f32 v26, v26, v26
    v_mul_f32 v27, v27, v27
    v_mul_f32 v28, v28, v28
    v_mul_f32 v29, v29, v29
    v_mul_f32 v30, v30, v30
    v_mul_f32 v31, v31, v31
    v_mul_f32 v32, v32, v32
    v_mul_f32 v33, v33, v33
    v_mul_f32 v26, s45, v26
    v_mul_f32 v27, s45, v27
    v_mul_f32 v28, s45, v28
    v_mul_f32 v29, s45, v29
    v_mul_f32 v30, s45, v30
    v_mul_f32 v31, s45, v31
    v_mul_f32 v32, s45, v32
    v_mul_f32 v33, s45, v33
    v_exp_f32 v26, v26
    v_exp_f32 v27, v27
    v_exp_f32 v28, v28
    v_exp_f32 v29, v29
    v_exp_f32 v30, v30
    v_exp_f32 v31, v31
    v_exp_f32 v32, v32
    v_exp_f32 v33, v33
    s_nop 0
    v_cvt_pk_f16_f32 v34, v26, v27
    v_cvt_pk_f16_f32 v35, v28, v29
    v_cvt_pk_f16_f32 v36, v30, v31
    v_cvt_pk_f16_f32 v37, v32, v33
    ds_write_b128 v125, v[34:37] offset:33568
    v_cmp_gt_u32 vcc, 53, v0
    s_and_saveexec_b64 s[52:53], vcc
    s_cbranch_execz P2_rbf3
    v_lshlrev_b32 v124, 16, v124
    v_subrev_f32 v26, s84, v124
    v_subrev_f32 v27, s85, v124
    v_subrev_f32 v28, s86, v124
    v_subrev_f32 v29, s87, v124
    v_subrev_f32 v30, s88, v124
    v_subrev_f32 v31, s89, v124
    v_subrev_f32 v32, s90, v124
    v_subrev_f32 v33, s91, v124
    v_mul_f32 v26, v26, v26
    v_mul_f32 v27, v27, v27
    v_mul_f32 v28, v28, v28
    v_mul_f32 v29, v29, v29
    v_mul_f32 v30, v30, v30
    v_mul_f32 v31, v31, v31
    v_mul_f32 v32, v32, v32
    v_mul_f32 v33, v33, v33
    v_mul_f32 v26, s45, v26
    v_mul_f32 v27, s45, v27
    v_mul_f32 v28, s45, v28
    v_mul_f32 v29, s45, v29
    v_mul_f32 v30, s45, v30
    v_mul_f32 v31, s45, v31
    v_mul_f32 v32, s45, v32
    v_mul_f32 v33, s45, v33
    v_exp_f32 v26, v26
    v_exp_f32 v27, v27
    v_exp_f32 v28, v28
    v_exp_f32 v29, v29
    v_exp_f32 v30, v30
    v_exp_f32 v31, v31
    v_exp_f32 v32, v32
    v_exp_f32 v33, v33
    s_nop 0
    v_cvt_pk_f16_f32 v34, v26, v27
    v_cvt_pk_f16_f32 v35, v28, v29
    v_cvt_pk_f16_f32 v36, v30, v31
    v_cvt_pk_f16_f32 v37, v32, v33
    ds_write_b128 v125, v[34:37] offset:49952
P2_rbf3:
    s_mov_b64 exec, s[52:53]
    s_cmp_eq_u32 s25, 0
    s_cbranch_scc0 P2_nopoll
    s_mov_b32 s96, 2097152
    v_mov_b32 v119, 0
P2_poll0:
    global_load_dword v120, v119, s[62:63] offset:0 sc1
    s_sub_u32 s96, s96, 1
    s_cbranch_scc1 P2_poll0x
    s_waitcnt vmcnt(0)
    v_readfirstlane_b32 s33, v120
    s_cmp_lt_u32 s33, 256
    s_cbranch_scc1 P2_poll0
P2_poll0x:
P2_nopoll:
    s_waitcnt vmcnt(0) lgkmcnt(0)
    s_barrier
    v_and_b32 v117, 15, v1
    v_lshrrev_b32 v118, 4, v1
    v_lshlrev_b32 v113, 3, v1
    v_lshlrev_b32 v119, 4, v118
    v_lshl_add_u32 v119, v117, 14, v119
    s_lshl_b32 s33, s24, 6
    s_lshl_b32 s34, s25, 18
    s_add_u32 s33, s33, s34
    v_lshrrev_b32 v120, 4, v1
    v_lshlrev_b32 v120, 14, v120
    s_add_u32 s34, s33, 65536
    buffer_load_dword v116, v120, s[16:19], s33 offen sc1
    buffer_load_dword v92, v120, s[16:19], s34 offen sc1
    buffer_load_dwordx4 v[94:97], v119, s[16:19], s33 offen sc1
    s_waitcnt vmcnt(0)
    s_call_b64 s[44:45], P2_w1
    v_lshrrev_b32 v106, 16, v116
    v_and_b32 v117, 1, v116
    v_and_b32 v118, 0xfffe, v116
    v_sub_u32 v101, v112, v117
    v_mad_u32_u24 v108, v118, 6, v111
    v_cmp_lt_i32 vcc, v101, v106
    v_cmp_lt_u32 s[48:49], 31, v106
    s_mov_b32 s55, s54
    v_cndmask_b32 v118, v115, v108, vcc
    v_add_u32 v110, 16, v110
    s_add_u32 s54, s54, 1200128
    s_add_u32 s58, s58, 1
    s_cmp_lt_u32 s58, 4
    s_cbranch_scc0 P2_adv1
P2_advr1:
    buffer_load_dwordx3 v[98:100], v118, s[8:11], s55 offen sc1
    v_mov_b32 v116, v92
    v_lshrrev_b32 v107, 16, v116
    v_and_b32 v117, 1, v116
    v_and_b32 v118, 0xfffe, v116
    v_sub_u32 v105, v112, v117
    v_mad_u32_u24 v109, v118, 6, v111
    v_cmp_lt_i32 vcc, v105, v107
    v_cmp_lt_u32 s[50:51], 31, v107
    s_mov_b32 s56, s54
    v_cndmask_b32 v118, v115, v109, vcc
    v_add_u32 v110, 16, v110
    s_add_u32 s54, s54, 1200128
    s_add_u32 s58, s58, 1
    s_cmp_lt_u32 s58, 4
    s_cbranch_scc0 P2_adv2
P2_advr2:
    buffer_load_dwordx3 v[102:104], v118, s[8:11], s56 offen sc1
    v_lshlrev_b32 v120, 4, v1
    s_mov_b32 s33, 4194304
    buffer_load_dwordx4 v[2:5], v120, s[16:19], s33 offen sc1
    s_mov_b32 s33, 4195328
    buffer_load_dwordx4 v[6:9], v120, s[16:19], s33 offen sc1
    s_mov_b32 s33, 4196352
    buffer_load_dwordx4 v[10:13], v120, s[16:19], s33 offen sc1
    s_mov_b32 s33, 4197376
    buffer_load_dwordx4 v[14:17], v120, s[16:19], s33 offen sc1
    ds_bpermute_b32 v116, v110, v94
    v_mov_b32 v91, 0
    v_mov_b32 v88, 0
    s_mov_b32 s57, 0
    s_waitcnt vmcnt(5)
    v_cmp_lt_u32 s[40:41], v101, v106
    v_add_u32 v118, 1, v101
    v_lshlrev_b32 v119, 16, v99
    v_cmp_lt_u32 s[42:43], v118, v106
    s_bcnt1_i32_b64 s81, s[40:41]
    v_mbcnt_lo_u32_b32 v117, s40, 0
    s_bcnt1_i32_b64 s32, s[42:43]
    v_mbcnt_hi_u32_b32 v117, s41, v117
    v_mbcnt_lo_u32_b32 v118, s42, 0
    s_add_u32 s33, s26, s81
    v_mbcnt_hi_u32_b32 v118, s43, v118
    s_add_u32 s33, s33, s32
    s_lshl3_add_u32 s34, s81, s27
    v_lshl_add_u32 v117, v117, 3, s27
    s_cmp_lg_u64 s[48:49], 0
    s_cselect_b32 s35, 0, 102
    v_lshl_add_u32 v118, v118, 3, s34
    s_cmp_ge_u32 s33, s35
    s_cbranch_scc1 P2_alt0
    s_mov_b64 exec, s[40:41]
    ds_write2_b32 v117, v98, v119 offset1:1
    s_mov_b64 exec, s[42:43]
    ds_write2_b32 v118, v100, v99 offset1:1
    s_mov_b64 exec, -1
    s_mov_b32 s26, s33
P2_slowr3:
    s_bcnt0_i32_b64 s32, s[98:99]
    s_not_b64 s[36:37], s[98:99]
    s_min_u32 s32, s26, s32
    v_mbcnt_lo_u32_b32 v119, s36, 0
    s_sub_u32 s26, s26, s32
    v_mbcnt_hi_u32_b32 v119, s37, v119
    s_lshl3_add_u32 s27, s26, s76
    v_cmp_gt_u32 vcc, s32, v119
    v_lshl_add_u32 v119, v119, 3, s27
    s_mov_b64 exec, s[36:37]
    v_mov_b32 v86, 0xfffff000
    v_mov_b32 v87, 0
    s_and_b64 exec, vcc, s[36:37]
    ds_read_b64 v[86:87], v119
    s_or_b64 s[28:29], exec, s[98:99]
    s_mov_b64 exec, -1
    s_waitcnt lgkmcnt(0)
    v_lshrrev_b32 v106, 16, v116
    v_and_b32 v117, 1, v116
    v_and_b32 v118, 0xfffe, v116
    v_sub_u32 v101, v112, v117
    v_mad_u32_u24 v108, v118, 6, v111
    v_cmp_lt_i32 vcc, v101, v106
    v_cmp_lt_u32 s[48:49], 31, v106
    s_mov_b32 s55, s54
    v_cndmask_b32 v118, v115, v108, vcc
    v_add_u32 v110, 16, v110
    s_add_u32 s54, s54, 1200128
    s_add_u32 s58, s58, 1
    s_cmp_lt_u32 s58, 4
    s_cbranch_scc0 P2_adv4
P2_advr4:
    ds_bpermute_b32 v116, v110, v94
    v_lshrrev_b32 v119, 7, v86
    s_and_b64 s[36:37], s[98:99], s[92:93]
    v_and_b32 v119, 0xffffffe0, v119
    s_lshl_b64 s[38:39], s[36:37], 1
    v_lshlrev_b32 v90, 4, v86
    v_and_b32 v121, s77, v87
    v_or_b32_dpp v120, v119, v114 quad_perm:[0,0,2,2] row_mask:0xf bank_mask:0xf
    v_or_b32_dpp v119, v119, v114 quad_perm:[1,1,3,3] row_mask:0xf bank_mask:0xf
    s_nor_b64 exec, s[36:37], s[38:39]
    s_andn2_b64 s[36:37], s[98:99], s[92:93]
    buffer_load_dwordx4 v[58:61], v120, s[12:15], 0 offen
    s_lshr_b64 s[38:39], s[36:37], 1
    s_nor_b64 exec, s[36:37], s[38:39]
    buffer_load_dwordx4 v[62:65], v119, s[12:15], 0 offen
    s_mov_b64 exec, -1
    buffer_load_dwordx3 v[98:100], v118, s[8:11], s55 offen sc1
    v_and_b32 v90, 0xfff0, v90
    v_mul_f32 v92, s79, v121
    v_mul_f32 v121, s80, v121
    v_fract_f32 v92, v92
    v_fract_f32 v121, v121
    v_cos_f32 v92, v92
    v_cos_f32 v121, v121
    s_nop 0
    v_cvt_pk_f16_f32 v92, v92, v121
    s_call_b64 s[46:47], P2_tail
    s_mov_b64 exec, 1
    s_add_u32 s83, s83, 16
    ds_inc_u32 v114, v115 offset:784
    s_mov_b64 exec, -1
    s_branch P2_step1
P2_tail:
    s_waitcnt lgkmcnt(0)
    s_setpc_b64 s[46:47]
P2_alt0:
    s_call_b64 s[46:47], P2_tail
P2_loop:
    s_waitcnt vmcnt(3)
    v_cmp_lt_u32 s[40:41], v101, v106
    v_add_u32 v118, 1, v101
    v_lshlrev_b32 v119, 16, v99
    v_cmp_lt_u32 s[42:43], v118, v106
    s_bcnt1_i32_b64 s81, s[40:41]
    v_mbcnt_lo_u32_b32 v117, s40, 0
    s_bcnt1_i32_b64 s32, s[42:43]
    v_mbcnt_hi_u32_b32 v117, s41, v117
    v_mbcnt_lo_u32_b32 v118, s42, 0
    s_add_u32 s33, s26, s81
    v_mbcnt_hi_u32_b32 v118, s43, v118
    s_add_u32 s33, s33, s32
    s_lshl3_add_u32 s34, s81, s27
    v_lshl_add_u32 v117, v117, 3, s27
    s_cmp_lg_u64 s[48:49], 0
    s_cselect_b32 s35, 0, 102
    v_lshl_add_u32 v118, v118, 3, s34
    s_cmp_ge_u32 s33, s35
    s_cbranch_scc1 P2_slow5
    s_mov_b64 exec, s[40:41]
    ds_write2_b32 v117, v98, v119 offset1:1
    s_mov_b64 exec, s[42:43]
    ds_write2_b32 v118, v100, v99 offset1:1
    s_mov_b64 exec, -1
    s_mov_b32 s26, s33
P2_slowr5:
    s_bcnt0_i32_b64 s32, s[98:99]
    s_not_b64 s[36:37], s[98:99]
    s_min_u32 s32, s26, s32
    v_mbcnt_lo_u32_b32 v119, s36, 0
    s_sub_u32 s26, s26, s32
    v_mbcnt_hi_u32_b32 v119, s37, v119
    s_lshl3_add_u32 s27, s26, s76
    v_cmp_gt_u32 vcc, s32, v119
    v_lshl_add_u32 v119, v119, 3, s27
    s_mov_b64 exec, s[36:37]
    v_mov_b32 v86, 0xfffff000
    v_mov_b32 v87, 0
    s_and_b64 exec, vcc, s[36:37]
    ds_read_b64 v[86:87], v119
    s_or_b64 s[28:29], exec, s[98:99]
    s_mov_b64 exec, -1
    ds_read_b128 v[82:85], v91 offset:800
    v_lshrrev_b32 v106, 16, v116
    v_and_b32 v117, 1, v116
    v_and_b32 v118, 0xfffe, v116
    v_sub_u32 v101, v112, v117
    v_mad_u32_u24 v108, v118, 6, v111
    v_cmp_lt_i32 vcc, v101, v106
    v_cmp_lt_u32 s[48:49], 31, v106
    s_mov_b32 s55, s54
    v_cndmask_b32 v118, v115, v108, vcc
    v_add_u32 v110, 16, v110
    s_add_u32 s54, s54, 1200128
    s_add_u32 s58, s58, 1
    s_cmp_lt_u32 s58, 4
    s_cbranch_scc0 P2_adv10
P2_advr10:
    ds_bpermute_b32 v116, v110, v94
    s_waitcnt lgkmcnt(2)
    v_lshrrev_b32 v119, 7, v86
    s_and_b64 s[36:37], s[98:99], s[92:93]
    v_and_b32 v119, 0xffffffe0, v119
    s_lshl_b64 s[38:39], s[36:37], 1
    v_lshlrev_b32 v90, 4, v86
    v_and_b32 v121, s77, v87
    v_or_b32_dpp v120, v119, v114 quad_perm:[0,0,2,2] row_mask:0xf bank_mask:0xf
    v_or_b32_dpp v119, v119, v114 quad_perm:[1,1,3,3] row_mask:0xf bank_mask:0xf
    s_nor_b64 exec, s[36:37], s[38:39]
    s_andn2_b64 s[36:37], s[98:99], s[92:93]
    buffer_load_dwordx4 v[58:61], v120, s[12:15], 0 offen
    s_lshr_b64 s[38:39], s[36:37], 1
    s_nor_b64 exec, s[36:37], s[38:39]
    buffer_load_dwordx4 v[62:65], v119, s[12:15], 0 offen
    s_mov_b64 exec, -1
    buffer_load_dwordx3 v[98:100], v118, s[8:11], s55 offen sc1
    s_waitcnt lgkmcnt(1)
    v_pk_mul_f16 v78, v82, v93 op_sel_hi:[1,0]
    v_pk_mul_f16 v79, v83, v93 op_sel_hi:[1,0]
    v_pk_mul_f16 v80, v84, v93 op_sel_hi:[1,0]
    v_pk_mul_f16 v81, v85, v93 op_sel_hi:[1,0]
    v_pk_mul_f16 v82, v82, v93 op_sel:[0,1]
    v_pk_mul_f16 v83, v83, v93 op_sel:[0,1]
    v_pk_mul_f16 v84, v84, v93 op_sel:[0,1]
    v_pk_mul_f16 v85, v85, v93 op_sel:[0,1]
    v_mfma_f32_32x32x16_f16 v[42:57], v[10:13], v[78:81], 0
    s_mov_b64 vcc, s[92:93]
    v_mfma_f32_32x32x16_f16 v[42:57], v[14:17], v[82:85], v[42:57]
    s_waitcnt vmcnt(4)
    v_cndmask_b32_dpp v78, v70, v66, vcc quad_perm:[0,0,2,2] row_mask:0xf bank_mask:0xf
    v_cndmask_b32_dpp v79, v71, v67, vcc quad_perm:[0,0,2,2] row_mask:0xf bank_mask:0xf
    v_cndmask_b32_dpp v80, v72, v68, vcc quad_perm:[0,0,2,2] row_mask:0xf bank_mask:0xf
    v_cndmask_b32_dpp v81, v73, v69, vcc quad_perm:[0,0,2,2] row_mask:0xf bank_mask:0xf
    s_not_b64 vcc, vcc
    v_cndmask_b32_dpp v82, v66, v70, vcc quad_perm:[1,1,3,3] row_mask:0xf bank_mask:0xf
    v_cndmask_b32_dpp v83, v67, v71, vcc quad_perm:[1,1,3,3] row_mask:0xf bank_mask:0xf
    v_cndmask_b32_dpp v84, v68, v72, vcc quad_perm:[1,1,3,3] row_mask:0xf bank_mask:0xf
    v_cndmask_b32_dpp v85, v69, v73, vcc quad_perm:[1,1,3,3] row_mask:0xf bank_mask:0xf
    v_mfma_f32_32x32x16_bf16 v[26:41], v[2:5], v[78:81], 0
    v_add_u32 v124, 50800, v91
    v_mfma_f32_32x32x16_bf16 v[26:41], v[6:9], v[82:85], v[26:41]
    v_add_u32 v125, 100800, v91
    v_lshrrev_b32 v122, 2, v88
    v_lshlrev_b32_e64 v123, v88, 1
    v_permlane32_swap_b32 v124, v125
    v_and_b32 v90, 0xfff0, v90
    v_mul_f32 v92, s79, v121
    v_mul_f32 v121, s80, v121
    v_fract_f32 v92, v92
    v_fract_f32 v121, v121
    v_cos_f32 v92, v92
    v_cos_f32 v121, v121
    v_and_b32 v122, 0x3fc, v122
    v_cvt_pk_f16_f32 v92, v92, v121
    s_setprio 3
    s_mov_b64 exec, s[30:31]
    ds_or_rtn_b32 v126, v122, v123
    s_mov_b64 exec, -1
    ds_read_b128 v[78:81], v124
    ds_read_b128 v[82:85], v125
    ds_read_b32 v127, v114 offset:784
    s_waitcnt lgkmcnt(2)
    v_and_b32 v126, v126, v123
    v_cmp_eq_u32 vcc, 0, v126
    s_and_b64 s[36:37], vcc, s[30:31]
    s_andn2_b64 s[100:101], s[30:31], vcc
    s_bcnt1_i32_b64 s32, s[100:101]
    s_mov_b32 exec_lo, s36
    s_mov_b32 exec_hi, s36
    s_cmp_gt_u32 s32, s97
    v_lshlrev_b32 v74, 16, v78
    v_and_b32 v75, s77, v78
    v_lshlrev_b32 v76, 16, v79
    v_and_b32 v77, s77, v79
    v_lshlrev_b32 v118, 16, v80
    v_and_b32 v119, s77, v80
    v_lshlrev_b32 v120, 16, v81
    v_and_b32 v121, s77, v81
    v_pk_fma_f32 v[74:75], v[26:27], v[42:43], v[74:75]
    v_pk_fma_f32 v[76:77], v[28:29], v[44:45], v[76:77]
    v_pk_fma_f32 v[118:119], v[30:31], v[46:47], v[118:119]
    v_pk_fma_f32 v[120:121], v[32:33], v[48:49], v[120:121]
    v_cvt_pk_bf16_f32 v78, v74, v75
    v_cvt_pk_bf16_f32 v79, v76, v77
    v_cvt_pk_bf16_f32 v80, v118, v119
    v_cvt_pk_bf16_f32 v81, v120, v121
    s_waitcnt lgkmcnt(1)
    ds_write_b128 v124, v[78:81]
    s_mov_b32 exec_lo, s37
    s_mov_b32 exec_hi, s37
    v_lshlrev_b32 v74, 16, v82
    v_and_b32 v75, s77, v82
    v_lshlrev_b32 v76, 16, v83
    v_and_b32 v77, s77, v83
    v_lshlrev_b32 v118, 16, v84
    v_and_b32 v119, s77, v84
    v_lshlrev_b32 v120, 16, v85
    v_and_b32 v121, s77, v85
    v_pk_fma_f32 v[74:75], v[34:35], v[50:51], v[74:75]
    v_pk_fma_f32 v[76:77], v[36:37], v[52:53], v[76:77]
    v_pk_fma_f32 v[118:119], v[38:39], v[54:55], v[118:119]
    v_pk_fma_f32 v[120:121], v[40:41], v[56:57], v[120:121]
    v_cvt_pk_bf16_f32 v82, v74, v75
    v_cvt_pk_bf16_f32 v83, v76, v77
    v_cvt_pk_bf16_f32 v84, v118, v119
    v_cvt_pk_bf16_f32 v85, v120, v121
    ds_write_b128 v125, v[82:85]
    s_mov_b64 exec, s[36:37]
    ds_xor_b32 v122, v123
    s_setprio 1
    s_mov_b64 exec, -1
    s_cbranch_scc1 P2_full11
P2_fullr11:
    s_waitcnt lgkmcnt(3)
    v_readfirstlane_b32 s34, v127
    s_mov_b64 exec, 1
    s_add_u32 s83, s83, 16
    ds_inc_u32 v114, v115 offset:784
    s_mov_b64 exec, -1
    s_cmp_lt_i32 s34, s83
    s_cbranch_scc1 P2_poll5
    s_sub_u32 s34, s34, 11
    s_cmp_lt_i32 s34, s83
    s_cbranch_scc1 P2_pollr5
    s_setprio 2
P2_pollr5:
P2_step1:
    s_waitcnt vmcnt(3)
    v_cmp_lt_u32 s[40:41], v105, v107
    v_add_u32 v118, 1, v105
    v_lshlrev_b32 v119, 16, v103
    v_cmp_lt_u32 s[42:43], v118, v107
    s_bcnt1_i32_b64 s81, s[40:41]
    v_mbcnt_lo_u32_b32 v117, s40, 0
    s_bcnt1_i32_b64 s32, s[42:43]
    v_mbcnt_hi_u32_b32 v117, s41, v117
    v_mbcnt_lo_u32_b32 v118, s42, 0
    s_add_u32 s33, s26, s81
    v_mbcnt_hi_u32_b32 v118, s43, v118
    s_add_u32 s33, s33, s32
    s_lshl3_add_u32 s34, s81, s27
    v_lshl_add_u32 v117, v117, 3, s27
    s_cmp_lg_u64 s[50:51], 0
    s_cselect_b32 s35, 0, 102
    v_lshl_add_u32 v118, v118, 3, s34
    s_cmp_ge_u32 s33, s35
    s_cbranch_scc1 P2_slow12
    s_mov_b64 exec, s[40:41]
    ds_write2_b32 v117, v102, v119 offset1:1
    s_mov_b64 exec, s[42:43]
    ds_write2_b32 v118, v104, v103 offset1:1
    s_mov_b64 exec, -1
    s_mov_b32 s26, s33
P2_slowr12:
    s_bcnt0_i32_b64 s32, s[100:101]
    s_not_b64 s[36:37], s[100:101]
    s_min_u32 s32, s26, s32
    v_mbcnt_lo_u32_b32 v119, s36, 0
    s_sub_u32 s26, s26, s32
    v_mbcnt_hi_u32_b32 v119, s37, v119
    s_lshl3_add_u32 s27, s26, s76
    v_cmp_gt_u32 vcc, s32, v119
    v_lshl_add_u32 v119, v119, 3, s27
    s_mov_b64 exec, s[36:37]
    v_mov_b32 v88, 0xfffff000
    v_mov_b32 v89, 0
    s_and_b64 exec, vcc, s[36:37]
    ds_read_b64 v[88:89], v119
    s_or_b64 s[30:31], exec, s[100:101]
    s_mov_b64 exec, -1
    ds_read_b128 v[82:85], v90 offset:800
    v_lshrrev_b32 v107, 16, v116
    v_and_b32 v117, 1, v116
    v_and_b32 v118, 0xfffe, v116
    v_sub_u32 v105, v112, v117
    v_mad_u32_u24 v109, v118, 6, v111
    v_cmp_lt_i32 vcc, v105, v107
    v_cmp_lt_u32 s[50:51], 31, v107
    s_mov_b32 s56, s54
    v_cndmask_b32 v118, v115, v109, vcc
    v_add_u32 v110, 16, v110
    s_add_u32 s54, s54, 1200128
    s_add_u32 s58, s58, 1
    s_cmp_lt_u32 s58, 4
    s_cbranch_scc0 P2_adv17
P2_advr17:
    ds_bpermute_b32 v116, v110, v94
    s_waitcnt lgkmcnt(2)
    v_lshrrev_b32 v119, 7, v88
    s_and_b64 s[36:37], s[100:101], s[92:93]
    v_and_b32 v119, 0xffffffe0, v119
    s_lshl_b64 s[38:39], s[36:37], 1
    v_lshlrev_b32 v91, 4, v88
    v_and_b32 v121, s77, v89
    v_or_b32_dpp v120, v119, v114 quad_perm:[0,0,2,2] row_mask:0xf bank_mask:0xf
    v_or_b32_dpp v119, v119, v114 quad_perm:[1,1,3,3] row_mask:0xf bank_mask:0xf
    s_nor_b64 exec, s[36:37], s[38:39]
    s_andn2_b64 s[36:37], s[100:101], s[92:93]
    buffer_load_dwordx4 v[66:69], v120, s[12:15], 0 offen
    s_lshr_b64 s[38:39], s[36:37], 1
    s_nor_b64 exec, s[36:37], s[38:39]
    buffer_load_dwordx4 v[70:73], v119, s[12:15], 0 offen
    s_mov_b64 exec, -1
    buffer_load_dwordx3 v[102:104], v118, s[8:11], s56 offen sc1
    s_waitcnt lgkmcnt(1)
    v_pk_mul_f16 v78, v82, v92 op_sel_hi:[1,0]
    v_pk_mul_f16 v79, v83, v92 op_sel_hi:[1,0]
    v_pk_mul_f16 v80, v84, v92 op_sel_hi:[1,0]
    v_pk_mul_f16 v81, v85, v92 op_sel_hi:[1,0]
    v_pk_mul_f16 v82, v82, v92 op_sel:[0,1]
    v_pk_mul_f16 v83, v83, v92 op_sel:[0,1]
    v_pk_mul_f16 v84, v84, v92 op_sel:[0,1]
    v_pk_mul_f16 v85, v85, v92 op_sel:[0,1]
    v_mfma_f32_32x32x16_f16 v[42:57], v[10:13], v[78:81], 0
    s_mov_b64 vcc, s[92:93]
    v_mfma_f32_32x32x16_f16 v[42:57], v[14:17], v[82:85], v[42:57]
    s_waitcnt vmcnt(4)
    v_cndmask_b32_dpp v78, v62, v58, vcc quad_perm:[0,0,2,2] row_mask:0xf bank_mask:0xf
    v_cndmask_b32_dpp v79, v63, v59, vcc quad_perm:[0,0,2,2] row_mask:0xf bank_mask:0xf
    v_cndmask_b32_dpp v80, v64, v60, vcc quad_perm:[0,0,2,2] row_mask:0xf bank_mask:0xf
    v_cndmask_b32_dpp v81, v65, v61, vcc quad_perm:[0,0,2,2] row_mask:0xf bank_mask:0xf
    s_not_b64 vcc, vcc
    v_cndmask_b32_dpp v82, v58, v62, vcc quad_perm:[1,1,3,3] row_mask:0xf bank_mask:0xf
    v_cndmask_b32_dpp v83, v59, v63, vcc quad_perm:[1,1,3,3] row_mask:0xf bank_mask:0xf
    v_cndmask_b32_dpp v84, v60, v64, vcc quad_perm:[1,1,3,3] row_mask:0xf bank_mask:0xf
    v_cndmask_b32_dpp v85, v61, v65, vcc quad_perm:[1,1,3,3] row_mask:0xf bank_mask:0xf
    v_mfma_f32_32x32x16_bf16 v[26:41], v[2:5], v[78:81], 0
    v_add_u32 v124, 50800, v90
    v_mfma_f32_32x32x16_bf16 v[26:41], v[6:9], v[82:85], v[26:41]
    v_add_u32 v125, 100800, v90
    v_lshrrev_b32 v122, 2, v86
    v_lshlrev_b32_e64 v123, v86, 1
    v_permlane32_swap_b32 v124, v125
    v_and_b32 v91, 0xfff0, v91
    v_mul_f32 v93, s79, v121
    v_mul_f32 v121, s80, v121
    v_fract_f32 v93, v93
    v_fract_f32 v121, v121
    v_cos_f32 v93, v93
    v_cos_f32 v121, v121
    v_and_b32 v122, 0x3fc, v122
    v_cvt_pk_f16_f32 v93, v93, v121
    s_setprio 3
    s_mov_b64 exec, s[28:29]
    ds_or_rtn_b32 v126, v122, v123
    s_mov_b64 exec, -1
    ds_read_b128 v[78:81], v124
    ds_read_b128 v[82:85], v125
    ds_read_b32 v127, v114 offset:784
    s_waitcnt lgkmcnt(2)
    v_and_b32 v126, v126, v123
    v_cmp_eq_u32 vcc, 0, v126
    s_and_b64 s[36:37], vcc, s[28:29]
    s_andn2_b64 s[98:99], s[28:29], vcc
    s_bcnt1_i32_b64 s32, s[98:99]
    s_mov_b32 exec_lo, s36
    s_mov_b32 exec_hi, s36
    s_cmp_gt_u32 s32, s97
    v_lshlrev_b32 v74, 16, v78
    v_and_b32 v75, s77, v78
    v_lshlrev_b32 v76, 16, v79
    v_and_b32 v77, s77, v79
    v_lshlrev_b32 v118, 16, v80
    v_and_b32 v119, s77, v80
    v_lshlrev_b32 v120, 16, v81
    v_and_b32 v121, s77, v81
    v_pk_fma_f32 v[74:75], v[26:27], v[42:43], v[74:75]
    v_pk_fma_f32 v[76:77], v[28:29], v[44:45], v[76:77]
    v_pk_fma_f32 v[118:119], v[30:31], v[46:47], v[118:119]
    v_pk_fma_f32 v[120:121], v[32:33], v[48:49], v[120:121]
    v_cvt_pk_bf16_f32 v78, v74, v75
    v_cvt_pk_bf16_f32 v79, v76, v77
    v_cvt_pk_bf16_f32 v80, v118, v119
    v_cvt_pk_bf16_f32 v81, v120, v121
    s_waitcnt lgkmcnt(1)
    ds_write_b128 v124, v[78:81]
    s_mov_b32 exec_lo, s37
    s_mov_b32 exec_hi, s37
    v_lshlrev_b32 v74, 16, v82
    v_and_b32 v75, s77, v82
    v_lshlrev_b32 v76, 16, v83
    v_and_b32 v77, s77, v83
    v_lshlrev_b32 v118, 16, v84
    v_and_b32 v119, s77, v84
    v_lshlrev_b32 v120, 16, v85
    v_and_b32 v121, s77, v85
    v_pk_fma_f32 v[74:75], v[34:35], v[50:51], v[74:75]
    v_pk_fma_f32 v[76:77], v[36:37], v[52:53], v[76:77]
    v_pk_fma_f32 v[118:119], v[38:39], v[54:55], v[118:119]
    v_pk_fma_f32 v[120:121], v[40:41], v[56:57], v[120:121]
    v_cvt_pk_bf16_f32 v82, v74, v75
    v_cvt_pk_bf16_f32 v83, v76, v77
    v_cvt_pk_bf16_f32 v84, v118, v119
    v_cvt_pk_bf16_f32 v85, v120, v121
    ds_write_b128 v125, v[82:85]
    s_mov_b64 exec, s[36:37]
    ds_xor_b32 v122, v123
    s_setprio 1
    s_mov_b64 exec, -1
    s_cbranch_scc1 P2_full18
P2_fullr18:
    s_waitcnt lgkmcnt(3)
    v_readfirstlane_b32 s34, v127
    s_mov_b64 exec, 1
    s_add_u32 s83, s83, 16
    ds_inc_u32 v114, v115 offset:784
    s_mov_b64 exec, -1
    s_cmp_lt_i32 s34, s83
    s_cbranch_scc1 P2_poll12
    s_sub_u32 s34, s34, 11
    s_cmp_lt_i32 s34, s83
    s_cbranch_scc1 P2_pollr12
    s_setprio 2
P2_pollr12:
    s_add_u32 s57, s57, 2
    s_cmp_lt_u32 s57, 52
    s_cbranch_scc1 P2_loop
    s_mov_b32 s97, 0
    s_bcnt0_i32_b64 s32, s[98:99]
    s_not_b64 s[36:37], s[98:99]
    s_min_u32 s32, s26, s32
    v_mbcnt_lo_u32_b32 v119, s36, 0
    s_sub_u32 s26, s26, s32
    v_mbcnt_hi_u32_b32 v119, s37, v119
    s_lshl3_add_u32 s27, s26, s76
    v_cmp_gt_u32 vcc, s32, v119
    v_lshl_add_u32 v119, v119, 3, s27
    s_mov_b64 exec, s[36:37]
    v_mov_b32 v86, 0xfffff000
    v_mov_b32 v87, 0
    s_and_b64 exec, vcc, s[36:37]
    ds_read_b64 v[86:87], v119
    s_or_b64 s[28:29], exec, s[98:99]
    s_mov_b64 exec, -1
    v_and_b32 v117, 31, v1
    v_lshrrev_b32 v118, 5, v1
    v_lshlrev_b32 v118, 4, v118
    s_lshl_b32 s33, s25, 10
    v_lshl_add_u32 v116, v117, 5, v118
    v_add_u32 v116, s33, v116
    s_mul_i32 s54, s24, 100000
    s_mov_b32 s58, s54
    v_lshlrev_b32 v117, 4, v1
    s_mov_b32 s33, 4200448
    s_mov_b32 s34, 4201472
    ds_read_b128 v[82:85], v91 offset:800
    s_waitcnt lgkmcnt(1)
    v_lshrrev_b32 v119, 7, v86
    s_and_b64 s[36:37], s[98:99], s[92:93]
    v_and_b32 v119, 0xffffffe0, v119
    s_lshl_b64 s[38:39], s[36:37], 1
    v_lshlrev_b32 v90, 4, v86
    v_and_b32 v121, s77, v87
    v_or_b32_dpp v120, v119, v114 quad_perm:[0,0,2,2] row_mask:0xf bank_mask:0xf
    v_or_b32_dpp v119, v119, v114 quad_perm:[1,1,3,3] row_mask:0xf bank_mask:0xf
    s_nor_b64 exec, s[36:37], s[38:39]
    s_andn2_b64 s[36:37], s[98:99], s[92:93]
    buffer_load_dwordx4 v[58:61], v120, s[12:15], 0 offen
    s_lshr_b64 s[38:39], s[36:37], 1
    s_nor_b64 exec, s[36:37], s[38:39]
    buffer_load_dwordx4 v[62:65], v119, s[12:15], 0 offen
    s_mov_b64 exec, -1
    buffer_load_dwordx4 v[22:25], v117, s[16:19], s33 offen sc1
    buffer_load_dwordx4 v[110:113], v117, s[16:19], s34 offen sc1
    s_mov_b32 s33, 4198400
    buffer_load_dwordx4 v[18:21], v117, s[16:19], s33 offen sc1
    buffer_load_dwordx4 v[94:97], v116, s[12:15], s58 offen
    s_add_u32 s58, s58, 16384
    s_waitcnt lgkmcnt(0)
    v_pk_mul_f16 v78, v82, v93 op_sel_hi:[1,0]
    v_pk_mul_f16 v79, v83, v93 op_sel_hi:[1,0]
    v_pk_mul_f16 v80, v84, v93 op_sel_hi:[1,0]
    v_pk_mul_f16 v81, v85, v93 op_sel_hi:[1,0]
    v_pk_mul_f16 v82, v82, v93 op_sel:[0,1]
    v_pk_mul_f16 v83, v83, v93 op_sel:[0,1]
    v_pk_mul_f16 v84, v84, v93 op_sel:[0,1]
    v_pk_mul_f16 v85, v85, v93 op_sel:[0,1]
    v_mfma_f32_32x32x16_f16 v[42:57], v[10:13], v[78:81], 0
    s_mov_b64 vcc, s[92:93]
    v_mfma_f32_32x32x16_f16 v[42:57], v[14:17], v[82:85], v[42:57]
    s_waitcnt vmcnt(6)
    buffer_load_dwordx4 v[98:101], v116, s[12:15], s58 offen
    s_add_u32 s58, s58, 16384
    buffer_load_dwordx4 v[102:105], v116, s[12:15], s58 offen
    s_add_u32 s58, s58, 16384
    buffer_load_dwordx4 v[106:109], v116, s[12:15], s58 offen
    s_add_u32 s58, s58, 16384
    v_cndmask_b32_dpp v78, v70, v66, vcc quad_perm:[0,0,2,2] row_mask:0xf bank_mask:0xf
    v_cndmask_b32_dpp v79, v71, v67, vcc quad_perm:[0,0,2,2] row_mask:0xf bank_mask:0xf
    v_cndmask_b32_dpp v80, v72, v68, vcc quad_perm:[0,0,2,2] row_mask:0xf bank_mask:0xf
    v_cndmask_b32_dpp v81, v73, v69, vcc quad_perm:[0,0,2,2] row_mask:0xf bank_mask:0xf
    s_not_b64 vcc, vcc
    v_cndmask_b32_dpp v82, v66, v70, vcc quad_perm:[1,1,3,3] row_mask:0xf bank_mask:0xf
    v_cndmask_b32_dpp v83, v67, v71, vcc quad_perm:[1,1,3,3] row_mask:0xf bank_mask:0xf
    v_cndmask_b32_dpp v84, v68, v72, vcc quad_perm:[1,1,3,3] row_mask:0xf bank_mask:0xf
    v_cndmask_b32_dpp v85, v69, v73, vcc quad_perm:[1,1,3,3] row_mask:0xf bank_mask:0xf
    v_mfma_f32_32x32x16_bf16 v[26:41], v[2:5], v[78:81], 0
    v_add_u32 v124, 50800, v91
    v_mfma_f32_32x32x16_bf16 v[26:41], v[6:9], v[82:85], v[26:41]
    v_add_u32 v125, 100800, v91
    v_lshrrev_b32 v122, 2, v88
    v_lshlrev_b32_e64 v123, v88, 1
    v_permlane32_swap_b32 v124, v125
    v_and_b32 v90, 0xfff0, v90
    v_mul_f32 v92, s79, v121
    v_mul_f32 v121, s80, v121
    v_fract_f32 v92, v92
    v_fract_f32 v121, v121
    v_cos_f32 v92, v92
    v_cos_f32 v121, v121
    v_and_b32 v122, 0x3fc, v122
    v_cvt_pk_f16_f32 v92, v92, v121
    s_call_b64 s[46:47], P2_rmw1
    s_cmp_eq_u64 s[28:29], 0
    s_cbranch_scc1 P2_drain
    ds_read_b128 v[82:85], v90 offset:800
    s_waitcnt lgkmcnt(0)
    v_pk_mul_f16 v78, v82, v92 op_sel_hi:[1,0]
    v_pk_mul_f16 v79, v83, v92 op_sel_hi:[1,0]
    v_pk_mul_f16 v80, v84, v92 op_sel_hi:[1,0]
    v_pk_mul_f16 v81, v85, v92 op_sel_hi:[1,0]
    v_pk_mul_f16 v82, v82, v92 op_sel:[0,1]
    v_pk_mul_f16 v83, v83, v92 op_sel:[0,1]
    v_pk_mul_f16 v84, v84, v92 op_sel:[0,1]
    v_pk_mul_f16 v85, v85, v92 op_sel:[0,1]
    v_mfma_f32_32x32x16_f16 v[42:57], v[10:13], v[78:81], 0
    s_mov_b64 vcc, s[92:93]
    v_mfma_f32_32x32x16_f16 v[42:57], v[14:17], v[82:85], v[42:57]
    s_waitcnt vmcnt(7)
    v_cndmask_b32_dpp v78, v62, v58, vcc quad_perm:[0,0,2,2] row_mask:0xf bank_mask:0xf
    v_cndmask_b32_dpp v79, v63, v59, vcc quad_perm:[0,0,2,2] row_mask:0xf bank_mask:0xf
    v_cndmask_b32_dpp v80, v64, v60, vcc quad_perm:[0,0,2,2] row_mask:0xf bank_mask:0xf
    v_cndmask_b32_dpp v81, v65, v61, vcc quad_perm:[0,0,2,2] row_mask:0xf bank_mask:0xf
    s_not_b64 vcc, vcc
    v_cndmask_b32_dpp v82, v58, v62, vcc quad_perm:[1,1,3,3] row_mask:0xf bank_mask:0xf
    v_cndmask_b32_dpp v83, v59, v63, vcc quad_perm:[1,1,3,3] row_mask:0xf bank_mask:0xf
    v_cndmask_b32_dpp v84, v60, v64, vcc quad_perm:[1,1,3,3] row_mask:0xf bank_mask:0xf
    v_cndmask_b32_dpp v85, v61, v65, vcc quad_perm:[1,1,3,3] row_mask:0xf bank_mask:0xf
    v_mfma_f32_32x32x16_bf16 v[26:41], v[2:5], v[78:81], 0
    v_add_u32 v124, 50800, v90
    v_mfma_f32_32x32x16_bf16 v[26:41], v[6:9], v[82:85], v[26:41]
    v_add_u32 v125, 100800, v90
    v_lshrrev_b32 v122, 2, v86
    v_lshlrev_b32_e64 v123, v86, 1
    v_permlane32_swap_b32 v124, v125
    s_nop 6
    v_and_b32 v122, 0x3fc, v122
    s_call_b64 s[46:47], P2_rmw0
P2_drain:
    s_cmp_eq_u32 s26, 0
    s_cbranch_scc1 P2_epi
    s_call_b64 s[44:45], P2_pop1
    s_branch P2_drain
P2_epi:
    buffer_load_dwordx4 v[66:69], v116, s[12:15], s58 offen
    s_add_u32 s58, s58, 16384
    buffer_load_dwordx4 v[70:73], v116, s[12:15], s58 offen
    s_add_u32 s58, s58, 16384
    buffer_load_dwordx4 v[86:89], v116, s[12:15], s58 offen
    s_add_u32 s58, s58, 16384
    s_lshl_b32 s33, s25, 9
    s_mov_b32 s35, 50800
    v_and_b32 v118, 31, v1
    v_lshlrev_b32 v118, 4, v118
    v_add_u32 v118, s33, v118
    v_lshrrev_b32 v117, 5, v1
    v_mul_u32_u24 v117, 50000, v117
    v_add3_u32 v117, v117, v118, s35
    s_waitcnt vmcnt(3) lgkmcnt(0)
    s_barrier
    ds_read_b128 v[78:81], v117 offset:0
    ds_read_b128 v[10:13], v118 offset:800
    ds_read_b128 v[82:85], v117 offset:8192
    ds_read_b128 v[14:17], v118 offset:8992
    s_waitcnt lgkmcnt(2)
    v_mfma_f32_32x32x16_bf16 v[26:41], v[22:25], v[78:81], 0
    v_mfma_f32_32x32x16_f16 v[26:41], v[110:113], v[10:13], v[26:41]
    s_waitcnt lgkmcnt(0)
    v_mfma_f32_32x32x16_bf16 v[42:57], v[22:25], v[82:85], 0
    v_mfma_f32_32x32x16_f16 v[42:57], v[110:113], v[14:17], v[42:57]
    ds_read_b128 v[2:5], v117 offset:16384
    ds_read_b128 v[6:9], v118 offset:17184
    ds_read_b128 v[58:61], v117 offset:24576
    ds_read_b128 v[62:65], v118 offset:25376
    s_nop 4
    v_pk_mul_f32 v[26:27], v[26:27], v[34:35]
    v_pk_mul_f32 v[28:29], v[28:29], v[36:37]
    v_pk_mul_f32 v[30:31], v[30:31], v[38:39]
    v_pk_mul_f32 v[32:33], v[32:33], v[40:41]
    v_pk_mul_f32 v[42:43], v[42:43], v[50:51]
    v_pk_mul_f32 v[44:45], v[44:45], v[52:53]
    v_pk_mul_f32 v[46:47], v[46:47], v[54:55]
    v_pk_mul_f32 v[48:49], v[48:49], v[56:57]
    s_nop 0
    v_mfma_f32_32x32x16_bf16 v[26:41], v[18:21], v[94:97], v[26:41]
    v_mfma_f32_32x32x16_bf16 v[42:57], v[18:21], v[98:101], v[42:57]
    s_nop 10
    v_cvt_pk_bf16_f32 v74, v26, v27
    v_cvt_pk_bf16_f32 v75, v28, v29
    v_cvt_pk_bf16_f32 v76, v30, v31
    v_cvt_pk_bf16_f32 v77, v32, v33
    buffer_store_dwordx4 v[74:77], v116, s[20:23], s54 offen nt
    s_add_u32 s54, s54, 16384
    v_cvt_pk_bf16_f32 v90, v42, v43
    v_cvt_pk_bf16_f32 v91, v44, v45
    v_cvt_pk_bf16_f32 v92, v46, v47
    v_cvt_pk_bf16_f32 v93, v48, v49
    buffer_store_dwordx4 v[90:93], v116, s[20:23], s54 offen nt
    s_add_u32 s54, s54, 16384
    s_waitcnt lgkmcnt(2)
    v_mfma_f32_32x32x16_bf16 v[26:41], v[22:25], v[2:5], 0
    v_mfma_f32_32x32x16_f16 v[26:41], v[110:113], v[6:9], v[26:41]
    s_waitcnt lgkmcnt(0)
    v_mfma_f32_32x32x16_bf16 v[42:57], v[22:25], v[58:61], 0
    v_mfma_f32_32x32x16_f16 v[42:57], v[110:113], v[62:65], v[42:57]
    ds_read_b128 v[78:81], v117 offset:32768
    ds_read_b128 v[10:13], v118 offset:33568
    ds_read_b128 v[82:85], v117 offset:40960
    ds_read_b128 v[14:17], v118 offset:41760
    s_nop 4
    v_pk_mul_f32 v[26:27], v[26:27], v[34:35]
    v_pk_mul_f32 v[28:29], v[28:29], v[36:37]
    v_pk_mul_f32 v[30:31], v[30:31], v[38:39]
    v_pk_mul_f32 v[32:33], v[32:33], v[40:41]
    v_pk_mul_f32 v[42:43], v[42:43], v[50:51]
    v_pk_mul_f32 v[44:45], v[44:45], v[52:53]
    v_pk_mul_f32 v[46:47], v[46:47], v[54:55]
    v_pk_mul_f32 v[48:49], v[48:49], v[56:57]
    s_nop 0
    v_mfma_f32_32x32x16_bf16 v[26:41], v[18:21], v[102:105], v[26:41]
    v_mfma_f32_32x32x16_bf16 v[42:57], v[18:21], v[106:109], v[42:57]
    s_nop 10
    v_cvt_pk_bf16_f32 v74, v26, v27
    v_cvt_pk_bf16_f32 v75, v28, v29
    v_cvt_pk_bf16_f32 v76, v30, v31
    v_cvt_pk_bf16_f32 v77, v32, v33
    buffer_store_dwordx4 v[74:77], v116, s[20:23], s54 offen nt
    s_add_u32 s54, s54, 16384
    v_cvt_pk_bf16_f32 v90, v42, v43
    v_cvt_pk_bf16_f32 v91, v44, v45
    v_cvt_pk_bf16_f32 v92, v46, v47
    v_cvt_pk_bf16_f32 v93, v48, v49
    buffer_store_dwordx4 v[90:93], v116, s[20:23], s54 offen nt
    s_add_u32 s54, s54, 16384
    s_waitcnt lgkmcnt(2)
    v_mfma_f32_32x32x16_bf16 v[26:41], v[22:25], v[78:81], 0
    v_mfma_f32_32x32x16_f16 v[26:41], v[110:113], v[10:13], v[26:41]
    s_waitcnt lgkmcnt(0)
    v_mfma_f32_32x32x16_bf16 v[42:57], v[22:25], v[82:85], 0
    v_mfma_f32_32x32x16_f16 v[42:57], v[110:113], v[14:17], v[42:57]
    ds_read_b128 v[2:5], v117 offset:49152
    ds_read_b128 v[6:9], v118 offset:49952
    s_nop 6
    v_pk_mul_f32 v[26:27], v[26:27], v[34:35]
    v_pk_mul_f32 v[28:29], v[28:29], v[36:37]
    v_pk_mul_f32 v[30:31], v[30:31], v[38:39]
    v_pk_mul_f32 v[32:33], v[32:33], v[40:41]
    v_pk_mul_f32 v[42:43], v[42:43], v[50:51]
    v_pk_mul_f32 v[44:45], v[44:45], v[52:53]
    v_pk_mul_f32 v[46:47], v[46:47], v[54:55]
    v_pk_mul_f32 v[48:49], v[48:49], v[56:57]
    s_waitcnt vmcnt(5)
    v_mfma_f32_32x32x16_bf16 v[26:41], v[18:21], v[66:69], v[26:41]
    v_mfma_f32_32x32x16_bf16 v[42:57], v[18:21], v[70:73], v[42:57]
    s_nop 10
    v_cvt_pk_bf16_f32 v74, v26, v27
    v_cvt_pk_bf16_f32 v75, v28, v29
    v_cvt_pk_bf16_f32 v76, v30, v31
    v_cvt_pk_bf16_f32 v77, v32, v33
    buffer_store_dwordx4 v[74:77], v116, s[20:23], s54 offen nt
    s_add_u32 s54, s54, 16384
    v_cvt_pk_bf16_f32 v90, v42, v43
    v_cvt_pk_bf16_f32 v91, v44, v45
    v_cvt_pk_bf16_f32 v92, v46, v47
    v_cvt_pk_bf16_f32 v93, v48, v49
    buffer_store_dwordx4 v[90:93], v116, s[20:23], s54 offen nt
    s_add_u32 s54, s54, 16384
    s_cmp_lt_u32 s25, 2
    s_cbranch_scc0 P2_done
    v_cmp_gt_u32 vcc, 1696, v116
    v_mov_b32 v119, 0x7fffff00
    s_nop 0
    v_cndmask_b32 v119, v119, v116, vcc
    s_waitcnt lgkmcnt(0)
    v_mfma_f32_32x32x16_bf16 v[26:41], v[22:25], v[2:5], 0
    v_mfma_f32_32x32x16_f16 v[26:41], v[110:113], v[6:9], v[26:41]
    s_nop 11
    v_pk_mul_f32 v[26:27], v[26:27], v[34:35]
    v_pk_mul_f32 v[28:29], v[28:29], v[36:37]
    v_pk_mul_f32 v[30:31], v[30:31], v[38:39]
    v_pk_mul_f32 v[32:33], v[32:33], v[40:41]
    s_waitcnt vmcnt(6)
    s_nop 0
    v_mfma_f32_32x32x16_bf16 v[26:41], v[18:21], v[86:89], v[26:41]
    s_nop 11
    v_cvt_pk_bf16_f32 v74, v26, v27
    v_cvt_pk_bf16_f32 v75, v28, v29
    v_cvt_pk_bf16_f32 v76, v30, v31
    v_cvt_pk_bf16_f32 v77, v32, v33
    buffer_store_dwordx4 v[74:77], v119, s[20:23], s54 offen nt
    s_add_u32 s54, s54, 16384
P2_done:
    s_endpgm
P2_pop0:
    s_bcnt0_i32_b64 s32, s[98:99]
    s_not_b64 s[36:37], s[98:99]
    s_min_u32 s32, s26, s32
    v_mbcnt_lo_u32_b32 v119, s36, 0
    s_sub_u32 s26, s26, s32
    v_mbcnt_hi_u32_b32 v119, s37, v119
    s_lshl3_add_u32 s27, s26, s76
    v_cmp_gt_u32 vcc, s32, v119
    v_lshl_add_u32 v119, v119, 3, s27
    s_mov_b64 exec, s[36:37]
    v_mov_b32 v86, 0xfffff000
    v_mov_b32 v87, 0
    s_and_b64 exec, vcc, s[36:37]
    ds_read_b64 v[86:87], v119
    s_or_b64 s[28:29], exec, s[98:99]
    s_mov_b64 exec, -1
    s_waitcnt lgkmcnt(0)
    v_lshrrev_b32 v119, 7, v86
    s_and_b64 s[36:37], s[98:99], s[92:93]
    v_and_b32 v119, 0xffffffe0, v119
    s_lshl_b64 s[38:39], s[36:37], 1
    v_lshlrev_b32 v90, 4, v86
    v_and_b32 v121, s77, v87
    v_or_b32_dpp v120, v119, v114 quad_perm:[0,0,2,2] row_mask:0xf bank_mask:0xf
    v_or_b32_dpp v119, v119, v114 quad_perm:[1,1,3,3] row_mask:0xf bank_mask:0xf
    s_nor_b64 exec, s[36:37], s[38:39]
    s_andn2_b64 s[36:37], s[98:99], s[92:93]
    buffer_load_dwordx4 v[58:61], v120, s[12:15], 0 offen
    s_lshr_b64 s[38:39], s[36:37], 1
    s_nor_b64 exec, s[36:37], s[38:39]
    buffer_load_dwordx4 v[62:65], v119, s[12:15], 0 offen
    s_mov_b64 exec, -1
    v_and_b32 v90, 0xfff0, v90
    v_mul_f32 v92, s79, v121
    v_mul_f32 v121, s80, v121
    v_fract_f32 v92, v92
    v_fract_f32 v121, v121
    v_cos_f32 v92, v92
    v_cos_f32 v121, v121
    ds_read_b128 v[82:85], v90 offset:800
    v_cvt_pk_f16_f32 v92, v92, v121
    s_mov_b64 s[46:47], s[44:45]
    s_waitcnt lgkmcnt(0)
    v_pk_mul_f16 v78, v82, v92 op_sel_hi:[1,0]
    v_pk_mul_f16 v79, v83, v92 op_sel_hi:[1,0]
    v_pk_mul_f16 v80, v84, v92 op_sel_hi:[1,0]
    v_pk_mul_f16 v81, v85, v92 op_sel_hi:[1,0]
    v_pk_mul_f16 v82, v82, v92 op_sel:[0,1]
    v_pk_mul_f16 v83, v83, v92 op_sel:[0,1]
    v_pk_mul_f16 v84, v84, v92 op_sel:[0,1]
    v_pk_mul_f16 v85, v85, v92 op_sel:[0,1]
    v_mfma_f32_32x32x16_f16 v[42:57], v[10:13], v[78:81], 0
    s_mov_b64 vcc, s[92:93]
    v_mfma_f32_32x32x16_f16 v[42:57], v[14:17], v[82:85], v[42:57]
    s_waitcnt vmcnt(0)
    v_cndmask_b32_dpp v78, v62, v58, vcc quad_perm:[0,0,2,2] row_mask:0xf bank_mask:0xf
    v_cndmask_b32_dpp v79, v63, v59, vcc quad_perm:[0,0,2,2] row_mask:0xf bank_mask:0xf
    v_cndmask_b32_dpp v80, v64, v60, vcc quad_perm:[0,0,2,2] row_mask:0xf bank_mask:0xf
    v_cndmask_b32_dpp v81, v65, v61, vcc quad_perm:[0,0,2,2] row_mask:0xf bank_mask:0xf
    s_not_b64 vcc, vcc
    v_cndmask_b32_dpp v82, v58, v62, vcc quad_perm:[1,1,3,3] row_mask:0xf bank_mask:0xf
    v_cndmask_b32_dpp v83, v59, v63, vcc quad_perm:[1,1,3,3] row_mask:0xf bank_mask:0xf
    v_cndmask_b32_dpp v84, v60, v64, vcc quad_perm:[1,1,3,3] row_mask:0xf bank_mask:0xf
    v_cndmask_b32_dpp v85, v61, v65, vcc quad_perm:[1,1,3,3] row_mask:0xf bank_mask:0xf
    v_mfma_f32_32x32x16_bf16 v[26:41], v[2:5], v[78:81], 0
    v_add_u32 v124, 50800, v90
    v_mfma_f32_32x32x16_bf16 v[26:41], v[6:9], v[82:85], v[26:41]
    v_add_u32 v125, 100800, v90
    v_lshrrev_b32 v122, 2, v86
    v_lshlrev_b32_e64 v123, v86, 1
    v_permlane32_swap_b32 v124, v125
    s_nop 6
    v_and_b32 v122, 0x3fc, v122
P2_rmw0:
    s_setprio 3
    s_mov_b64 exec, s[28:29]
    ds_or_rtn_b32 v126, v122, v123
    s_mov_b64 exec, -1
    ds_read_b128 v[78:81], v124
    ds_read_b128 v[82:85], v125
    s_waitcnt lgkmcnt(1)
    v_and_b32 v126, v126, v123
    v_cmp_eq_u32 vcc, 0, v126
    s_and_b64 s[36:37], vcc, s[28:29]
    s_andn2_b64 s[98:99], s[28:29], vcc
    s_bcnt1_i32_b64 s32, s[98:99]
    s_mov_b32 exec_lo, s36
    s_mov_b32 exec_hi, s36
    s_cmp_gt_u32 s32, s97
    v_lshlrev_b32 v74, 16, v78
    v_and_b32 v75, s77, v78
    v_lshlrev_b32 v76, 16, v79
    v_and_b32 v77, s77, v79
    v_lshlrev_b32 v118, 16, v80
    v_and_b32 v119, s77, v80
    v_lshlrev_b32 v120, 16, v81
    v_and_b32 v121, s77, v81
    v_pk_fma_f32 v[74:75], v[26:27], v[42:43], v[74:75]
    v_pk_fma_f32 v[76:77], v[28:29], v[44:45], v[76:77]
    v_pk_fma_f32 v[118:119], v[30:31], v[46:47], v[118:119]
    v_pk_fma_f32 v[120:121], v[32:33], v[48:49], v[120:121]
    v_cvt_pk_bf16_f32 v78, v74, v75
    v_cvt_pk_bf16_f32 v79, v76, v77
    v_cvt_pk_bf16_f32 v80, v118, v119
    v_cvt_pk_bf16_f32 v81, v120, v121
    s_waitcnt lgkmcnt(0)
    ds_write_b128 v124, v[78:81]
    s_mov_b32 exec_lo, s37
    s_mov_b32 exec_hi, s37
    v_lshlrev_b32 v74, 16, v82
    v_and_b32 v75, s77, v82
    v_lshlrev_b32 v76, 16, v83
    v_and_b32 v77, s77, v83
    v_lshlrev_b32 v118, 16, v84
    v_and_b32 v119, s77, v84
    v_lshlrev_b32 v120, 16, v85
    v_and_b32 v121, s77, v85
    v_pk_fma_f32 v[74:75], v[34:35], v[50:51], v[74:75]
    v_pk_fma_f32 v[76:77], v[36:37], v[52:53], v[76:77]
    v_pk_fma_f32 v[118:119], v[38:39], v[54:55], v[118:119]
    v_pk_fma_f32 v[120:121], v[40:41], v[56:57], v[120:121]
    v_cvt_pk_bf16_f32 v82, v74, v75
    v_cvt_pk_bf16_f32 v83, v76, v77
    v_cvt_pk_bf16_f32 v84, v118, v119
    v_cvt_pk_bf16_f32 v85, v120, v121
    ds_write_b128 v125, v[82:85]
    s_mov_b64 exec, s[36:37]
    ds_xor_b32 v122, v123
    s_setprio 1
    s_mov_b64 exec, -1
    s_cbranch_scc1 P2_full19
    s_setpc_b64 s[46:47]
P2_full19:
    s_mov_b64 s[28:29], s[98:99]
    s_branch P2_rmw0
P2_pop1:
    s_bcnt0_i32_b64 s32, s[100:101]
    s_not_b64 s[36:37], s[100:101]
    s_min_u32 s32, s26, s32
    v_mbcnt_lo_u32_b32 v119, s36, 0
    s_sub_u32 s26, s26, s32
    v_mbcnt_hi_u32_b32 v119, s37, v119
    s_lshl3_add_u32 s27, s26, s76
    v_cmp_gt_u32 vcc, s32, v119
    v_lshl_add_u32 v119, v119, 3, s27
    s_mov_b64 exec, s[36:37]
    v_mov_b32 v88, 0xfffff000
    v_mov_b32 v89, 0
    s_and_b64 exec, vcc, s[36:37]
    ds_read_b64 v[88:89], v119
    s_or_b64 s[30:31], exec, s[100:101]
    s_mov_b64 exec, -1
    s_waitcnt lgkmcnt(0)
    v_lshrrev_b32 v119, 7, v88
    s_and_b64 s[36:37], s[100:101], s[92:93]
    v_and_b32 v119, 0xffffffe0, v119
    s_lshl_b64 s[38:39], s[36:37], 1
    v_lshlrev_b32 v91, 4, v88
    v_and_b32 v121, s77, v89
    v_or_b32_dpp v120, v119, v114 quad_perm:[0,0,2,2] row_mask:0xf bank_mask:0xf
    v_or_b32_dpp v119, v119, v114 quad_perm:[1,1,3,3] row_mask:0xf bank_mask:0xf
    s_nor_b64 exec, s[36:37], s[38:39]
    s_andn2_b64 s[36:37], s[100:101], s[92:93]
    buffer_load_dwordx4 v[66:69], v120, s[12:15], 0 offen
    s_lshr_b64 s[38:39], s[36:37], 1
    s_nor_b64 exec, s[36:37], s[38:39]
    buffer_load_dwordx4 v[70:73], v119, s[12:15], 0 offen
    s_mov_b64 exec, -1
    v_and_b32 v91, 0xfff0, v91
    v_mul_f32 v93, s79, v121
    v_mul_f32 v121, s80, v121
    v_fract_f32 v93, v93
    v_fract_f32 v121, v121
    v_cos_f32 v93, v93
    v_cos_f32 v121, v121
    ds_read_b128 v[82:85], v91 offset:800
    v_cvt_pk_f16_f32 v93, v93, v121
    s_mov_b64 s[46:47], s[44:45]
    s_waitcnt lgkmcnt(0)
    v_pk_mul_f16 v78, v82, v93 op_sel_hi:[1,0]
    v_pk_mul_f16 v79, v83, v93 op_sel_hi:[1,0]
    v_pk_mul_f16 v80, v84, v93 op_sel_hi:[1,0]
    v_pk_mul_f16 v81, v85, v93 op_sel_hi:[1,0]
    v_pk_mul_f16 v82, v82, v93 op_sel:[0,1]
    v_pk_mul_f16 v83, v83, v93 op_sel:[0,1]
    v_pk_mul_f16 v84, v84, v93 op_sel:[0,1]
    v_pk_mul_f16 v85, v85, v93 op_sel:[0,1]
    v_mfma_f32_32x32x16_f16 v[42:57], v[10:13], v[78:81], 0
    s_mov_b64 vcc, s[92:93]
    v_mfma_f32_32x32x16_f16 v[42:57], v[14:17], v[82:85], v[42:57]
    s_waitcnt vmcnt(0)
    v_cndmask_b32_dpp v78, v70, v66, vcc quad_perm:[0,0,2,2] row_mask:0xf bank_mask:0xf
    v_cndmask_b32_dpp v79, v71, v67, vcc quad_perm:[0,0,2,2] row_mask:0xf bank_mask:0xf
    v_cndmask_b32_dpp v80, v72, v68, vcc quad_perm:[0,0,2,2] row_mask:0xf bank_mask:0xf
    v_cndmask_b32_dpp v81, v73, v69, vcc quad_perm:[0,0,2,2] row_mask:0xf bank_mask:0xf
    s_not_b64 vcc, vcc
    v_cndmask_b32_dpp v82, v66, v70, vcc quad_perm:[1,1,3,3] row_mask:0xf bank_mask:0xf
    v_cndmask_b32_dpp v83, v67, v71, vcc quad_perm:[1,1,3,3] row_mask:0xf bank_mask:0xf
    v_cndmask_b32_dpp v84, v68, v72, vcc quad_perm:[1,1,3,3] row_mask:0xf bank_mask:0xf
    v_cndmask_b32_dpp v85, v69, v73, vcc quad_perm:[1,1,3,3] row_mask:0xf bank_mask:0xf
    v_mfma_f32_32x32x16_bf16 v[26:41], v[2:5], v[78:81], 0
    v_add_u32 v124, 50800, v91
    v_mfma_f32_32x32x16_bf16 v[26:41], v[6:9], v[82:85], v[26:41]
    v_add_u32 v125, 100800, v91
    v_lshrrev_b32 v122, 2, v88
    v_lshlrev_b32_e64 v123, v88, 1
    v_permlane32_swap_b32 v124, v125
    s_nop 6
    v_and_b32 v122, 0x3fc, v122
P2_rmw1:
    s_setprio 3
    s_mov_b64 exec, s[30:31]
    ds_or_rtn_b32 v126, v122, v123
    s_mov_b64 exec, -1
    ds_read_b128 v[78:81], v124
    ds_read_b128 v[82:85], v125
    s_waitcnt lgkmcnt(1)
    v_and_b32 v126, v126, v123
    v_cmp_eq_u32 vcc, 0, v126
    s_and_b64 s[36:37], vcc, s[30:31]
    s_andn2_b64 s[100:101], s[30:31], vcc
    s_bcnt1_i32_b64 s32, s[100:101]
    s_mov_b32 exec_lo, s36
    s_mov_b32 exec_hi, s36
    s_cmp_gt_u32 s32, s97
    v_lshlrev_b32 v74, 16, v78
    v_and_b32 v75, s77, v78
    v_lshlrev_b32 v76, 16, v79
    v_and_b32 v77, s77, v79
    v_lshlrev_b32 v118, 16, v80
    v_and_b32 v119, s77, v80
    v_lshlrev_b32 v120, 16, v81
    v_and_b32 v121, s77, v81
    v_pk_fma_f32 v[74:75], v[26:27], v[42:43], v[74:75]
    v_pk_fma_f32 v[76:77], v[28:29], v[44:45], v[76:77]
    v_pk_fma_f32 v[118:119], v[30:31], v[46:47], v[118:119]
    v_pk_fma_f32 v[120:121], v[32:33], v[48:49], v[120:121]
    v_cvt_pk_bf16_f32 v78, v74, v75
    v_cvt_pk_bf16_f32 v79, v76, v77
    v_cvt_pk_bf16_f32 v80, v118, v119
    v_cvt_pk_bf16_f32 v81, v120, v121
    s_waitcnt lgkmcnt(0)
    ds_write_b128 v124, v[78:81]
    s_mov_b32 exec_lo, s37
    s_mov_b32 exec_hi, s37
    v_lshlrev_b32 v74, 16, v82
    v_and_b32 v75, s77, v82
    v_lshlrev_b32 v76, 16, v83
    v_and_b32 v77, s77, v83
    v_lshlrev_b32 v118, 16, v84
    v_and_b32 v119, s77, v84
    v_lshlrev_b32 v120, 16, v85
    v_and_b32 v121, s77, v85
    v_pk_fma_f32 v[74:75], v[34:35], v[50:51], v[74:75]
    v_pk_fma_f32 v[76:77], v[36:37], v[52:53], v[76:77]
    v_pk_fma_f32 v[118:119], v[38:39], v[54:55], v[118:119]
    v_pk_fma_f32 v[120:121], v[40:41], v[56:57], v[120:121]
    v_cvt_pk_bf16_f32 v82, v74, v75
    v_cvt_pk_bf16_f32 v83, v76, v77
    v_cvt_pk_bf16_f32 v84, v118, v119
    v_cvt_pk_bf16_f32 v85, v120, v121
    ds_write_b128 v125, v[82:85]
    s_mov_b64 exec, s[36:37]
    ds_xor_b32 v122, v123
    s_setprio 1
    s_mov_b64 exec, -1
    s_cbranch_scc1 P2_full20
    s_setpc_b64 s[46:47]
P2_full20:
    s_mov_b64 s[30:31], s[100:101]
    s_branch P2_rmw1
P2_adv1:
    s_mov_b32 s58, 0
    s_sub_u32 s54, s54, 4800512
    s_add_u32 s59, s59, 1
    s_and_b32 s33, s59, 3
    s_cselect_b32 s33, 64, 0
    v_subrev_u32 v110, s33, v110
    v_mov_b32 v117, v94
    v_mov_b32 v94, v95
    v_mov_b32 v95, v96
    v_mov_b32 v96, v97
    v_mov_b32 v97, v117
    s_call_b64 s[44:45], P2_w1
    s_cmp_lt_u32 s59, 16
    s_cbranch_scc1 P2_advr1
    v_mov_b32 v94, 0
    s_branch P2_advr1
P2_adv2:
    s_mov_b32 s58, 0
    s_sub_u32 s54, s54, 4800512
    s_add_u32 s59, s59, 1
    s_and_b32 s33, s59, 3
    s_cselect_b32 s33, 64, 0
    v_subrev_u32 v110, s33, v110
    v_mov_b32 v117, v94
    v_mov_b32 v94, v95
    v_mov_b32 v95, v96
    v_mov_b32 v96, v97
    v_mov_b32 v97, v117
    s_call_b64 s[44:45], P2_w1
    s_cmp_lt_u32 s59, 16
    s_cbranch_scc1 P2_advr2
    v_mov_b32 v94, 0
    s_branch P2_advr2
P2_w1:
    s_cmp_eq_u32 s82, 1
    s_cbranch_scc1 P2_w1r
    v_and_b32 v119, 0xffff, v94
    v_lshrrev_b32 v120, 16, v94
    v_add_u32 v119, v119, v120
    s_lshr_b32 s33, s59, 2
    s_lshl_b32 s33, s33, 4
    v_cmp_lt_u32 vcc, 25984, v119
    s_lshr_b64 vcc, vcc, s33
    s_and_b32 s33, vcc_lo, 0xffff
    s_cbranch_scc0 P2_w1r
    s_mov_b32 s82, 1
    v_mov_b32 v119, 0
    v_mov_b32 v120, 1
    s_mov_b64 exec, 1
    ds_or_rtn_b32 v120, v119, v120 offset:788
    s_mov_b64 exec, -1
    s_waitcnt lgkmcnt(0)
    v_readfirstlane_b32 s33, v120
    s_cmp_eq_u32 s33, 0
    s_cbranch_scc0 P2_w1o
    s_mov_b32 s96, 2097152
    v_mov_b32 v119, 0
P2_poll1:
    global_load_dword v120, v119, s[62:63] offset:128 sc1
    s_sub_u32 s96, s96, 1
    s_cbranch_scc1 P2_poll1x
    s_waitcnt vmcnt(0)
    v_readfirstlane_b32 s33, v120
    s_cmp_lt_u32 s33, 256
    s_cbranch_scc1 P2_poll1
P2_poll1x:
    s_waitcnt vmcnt(0)
    v_mov_b32 v120, 3
    ds_write_b32 v119, v120 offset:788
P2_w1r:
    s_setpc_b64 s[44:45]
P2_w1o:
    s_cmp_eq_u32 s33, 3
    s_cbranch_scc1 P2_w1r
    ds_read_b32 v120, v119 offset:788
    s_waitcnt lgkmcnt(0)
    v_readfirstlane_b32 s33, v120
    s_branch P2_w1o
P2_adv4:
    s_mov_b32 s58, 0
    s_sub_u32 s54, s54, 4800512
    s_add_u32 s59, s59, 1
    s_and_b32 s33, s59, 3
    s_cselect_b32 s33, 64, 0
    v_subrev_u32 v110, s33, v110
    v_mov_b32 v117, v94
    v_mov_b32 v94, v95
    v_mov_b32 v95, v96
    v_mov_b32 v96, v97
    v_mov_b32 v97, v117
    s_call_b64 s[44:45], P2_w1
    s_cmp_lt_u32 s59, 16
    s_cbranch_scc1 P2_advr4
    v_mov_b32 v94, 0
    s_branch P2_advr4
P2_slow5:
    v_cmp_lt_u32 s[40:41], v101, v106
    v_lshlrev_b32 v0, 16, v99
P2_push6:
    s_bcnt1_i32_b64 s81, s[40:41]
    s_add_u32 s33, s26, s81
    s_cmp_le_u32 s33, 101
    s_cbranch_scc1 P2_pok6
    s_call_b64 s[44:45], P2_pop0
    s_branch P2_push6
P2_pok6:
    v_mbcnt_lo_u32_b32 v121, s40, 0
    v_mbcnt_hi_u32_b32 v121, s41, v121
    v_lshl_add_u32 v121, v121, 3, s27
    s_mov_b64 exec, s[40:41]
    ds_write2_b32 v121, v98, v0 offset1:1
    s_mov_b64 exec, -1
    s_mov_b32 s26, s33
    s_lshl3_add_u32 s27, s81, s27
    v_add_u32 v0, 1, v101
    v_cmp_lt_u32 s[40:41], v0, v106
P2_push7:
    s_bcnt1_i32_b64 s81, s[40:41]
    s_add_u32 s33, s26, s81
    s_cmp_le_u32 s33, 101
    s_cbranch_scc1 P2_pok7
    s_call_b64 s[44:45], P2_pop0
    s_branch P2_push7
P2_pok7:
    v_mbcnt_lo_u32_b32 v121, s40, 0
    v_mbcnt_hi_u32_b32 v121, s41, v121
    v_lshl_add_u32 v121, v121, 3, s27
    s_mov_b64 exec, s[40:41]
    ds_write2_b32 v121, v100, v99 offset1:1
    s_mov_b64 exec, -1
    s_mov_b32 s26, s33
    s_lshl3_add_u32 s27, s81, s27
P2_long5:
    v_add_u32 v101, 32, v101
    v_add_u32 v108, 192, v108
    v_cmp_lt_i32 vcc, v101, v106
    s_cbranch_vccz P2_slowr5
    s_nop 0
    v_cndmask_b32 v121, v115, v108, vcc
    buffer_load_dwordx3 v[98:100], v121, s[8:11], s55 offen sc1
    s_waitcnt vmcnt(0)
    v_cmp_lt_u32 s[40:41], v101, v106
    v_lshlrev_b32 v0, 16, v99
P2_push8:
    s_bcnt1_i32_b64 s81, s[40:41]
    s_add_u32 s33, s26, s81
    s_cmp_le_u32 s33, 101
    s_cbranch_scc1 P2_pok8
    s_call_b64 s[44:45], P2_pop0
    s_branch P2_push8
P2_pok8:
    v_mbcnt_lo_u32_b32 v121, s40, 0
    v_mbcnt_hi_u32_b32 v121, s41, v121
    v_lshl_add_u32 v121, v121, 3, s27
    s_mov_b64 exec, s[40:41]
    ds_write2_b32 v121, v98, v0 offset1:1
    s_mov_b64 exec, -1
    s_mov_b32 s26, s33
    s_lshl3_add_u32 s27, s81, s27
    v_add_u32 v0, 1, v101
    v_cmp_lt_u32 s[40:41], v0, v106
P2_push9:
    s_bcnt1_i32_b64 s81, s[40:41]
    s_add_u32 s33, s26, s81
    s_cmp_le_u32 s33, 101
    s_cbranch_scc1 P2_pok9
    s_call_b64 s[44:45], P2_pop0
    s_branch P2_push9
P2_pok9:
    v_mbcnt_lo_u32_b32 v121, s40, 0
    v_mbcnt_hi_u32_b32 v121, s41, v121
    v_lshl_add_u32 v121, v121, 3, s27
    s_mov_b64 exec, s[40:41]
    ds_write2_b32 v121, v100, v99 offset1:1
    s_mov_b64 exec, -1
    s_mov_b32 s26, s33
    s_lshl3_add_u32 s27, s81, s27
    s_branch P2_long5
P2_adv10:
    s_mov_b32 s58, 0
    s_sub_u32 s54, s54, 4800512
    s_add_u32 s59, s59, 1
    s_and_b32 s33, s59, 3
    s_cselect_b32 s33, 64, 0
    v_subrev_u32 v110, s33, v110
    v_mov_b32 v117, v94
    v_mov_b32 v94, v95
    v_mov_b32 v95, v96
    v_mov_b32 v96, v97
    v_mov_b32 v97, v117
    s_call_b64 s[44:45], P2_w1
    s_cmp_lt_u32 s59, 16
    s_cbranch_scc1 P2_advr10
    v_mov_b32 v94, 0
    s_branch P2_advr10
P2_full11:
    s_mov_b64 s[30:31], s[100:101]
    s_call_b64 s[46:47], P2_rmw1
    s_branch P2_fullr11
P2_poll5:
    s_setprio 0
    s_mov_b64 exec, 1
    ds_read_b32 v127, v114 offset:784
    s_mov_b64 exec, -1
    s_waitcnt lgkmcnt(0)
    v_readfirstlane_b32 s34, v127
    s_cmp_ge_i32 s34, s83
    s_setprio 1
    s_cbranch_scc1 P2_pollr5
    s_branch P2_poll5
P2_slow12:
    v_cmp_lt_u32 s[40:41], v105, v107
    v_lshlrev_b32 v0, 16, v103
P2_push13:
    s_bcnt1_i32_b64 s81, s[40:41]
    s_add_u32 s33, s26, s81
    s_cmp_le_u32 s33, 101
    s_cbranch_scc1 P2_pok13
    s_call_b64 s[44:45], P2_pop1
    s_branch P2_push13
P2_pok13:
    v_mbcnt_lo_u32_b32 v121, s40, 0
    v_mbcnt_hi_u32_b32 v121, s41, v121
    v_lshl_add_u32 v121, v121, 3, s27
    s_mov_b64 exec, s[40:41]
    ds_write2_b32 v121, v102, v0 offset1:1
    s_mov_b64 exec, -1
    s_mov_b32 s26, s33
    s_lshl3_add_u32 s27, s81, s27
    v_add_u32 v0, 1, v105
    v_cmp_lt_u32 s[40:41], v0, v107
P2_push14:
    s_bcnt1_i32_b64 s81, s[40:41]
    s_add_u32 s33, s26, s81
    s_cmp_le_u32 s33, 101
    s_cbranch_scc1 P2_pok14
    s_call_b64 s[44:45], P2_pop1
    s_branch P2_push14
P2_pok14:
    v_mbcnt_lo_u32_b32 v121, s40, 0
    v_mbcnt_hi_u32_b32 v121, s41, v121
    v_lshl_add_u32 v121, v121, 3, s27
    s_mov_b64 exec, s[40:41]
    ds_write2_b32 v121, v104, v103 offset1:1
    s_mov_b64 exec, -1
    s_mov_b32 s26, s33
    s_lshl3_add_u32 s27, s81, s27
P2_long12:
    v_add_u32 v105, 32, v105
    v_add_u32 v109, 192, v109
    v_cmp_lt_i32 vcc, v105, v107
    s_cbranch_vccz P2_slowr12
    s_nop 0
    v_cndmask_b32 v121, v115, v109, vcc
    buffer_load_dwordx3 v[102:104], v121, s[8:11], s56 offen sc1
    s_waitcnt vmcnt(0)
    v_cmp_lt_u32 s[40:41], v105, v107
    v_lshlrev_b32 v0, 16, v103
P2_push15:
    s_bcnt1_i32_b64 s81, s[40:41]
    s_add_u32 s33, s26, s81
    s_cmp_le_u32 s33, 101
    s_cbranch_scc1 P2_pok15
    s_call_b64 s[44:45], P2_pop1
    s_branch P2_push15
P2_pok15:
    v_mbcnt_lo_u32_b32 v121, s40, 0
    v_mbcnt_hi_u32_b32 v121, s41, v121
    v_lshl_add_u32 v121, v121, 3, s27
    s_mov_b64 exec, s[40:41]
    ds_write2_b32 v121, v102, v0 offset1:1
    s_mov_b64 exec, -1
    s_mov_b32 s26, s33
    s_lshl3_add_u32 s27, s81, s27
    v_add_u32 v0, 1, v105
    v_cmp_lt_u32 s[40:41], v0, v107
P2_push16:
    s_bcnt1_i32_b64 s81, s[40:41]
    s_add_u32 s33, s26, s81
    s_cmp_le_u32 s33, 101
    s_cbranch_scc1 P2_pok16
    s_call_b64 s[44:45], P2_pop1
    s_branch P2_push16
P2_pok16:
    v_mbcnt_lo_u32_b32 v121, s40, 0
    v_mbcnt_hi_u32_b32 v121, s41, v121
    v_lshl_add_u32 v121, v121, 3, s27
    s_mov_b64 exec, s[40:41]
    ds_write2_b32 v121, v104, v103 offset1:1
    s_mov_b64 exec, -1
    s_mov_b32 s26, s33
    s_lshl3_add_u32 s27, s81, s27
    s_branch P2_long12
P2_adv17:
    s_mov_b32 s58, 0
    s_sub_u32 s54, s54, 4800512
    s_add_u32 s59, s59, 1
    s_and_b32 s33, s59, 3
    s_cselect_b32 s33, 64, 0
    v_subrev_u32 v110, s33, v110
    v_mov_b32 v117, v94
    v_mov_b32 v94, v95
    v_mov_b32 v95, v96
    v_mov_b32 v96, v97
    v_mov_b32 v97, v117
    s_call_b64 s[44:45], P2_w1
    s_cmp_lt_u32 s59, 16
    s_cbranch_scc1 P2_advr17
    v_mov_b32 v94, 0
    s_branch P2_advr17
P2_full18:
    s_mov_b64 s[28:29], s[98:99]
    s_call_b64 s[46:47], P2_rmw0
    s_branch P2_fullr18
P2_poll12:
    s_setprio 0
    s_mov_b64 exec, 1
    ds_read_b32 v127, v114 offset:784
    s_mov_b64 exec, -1
    s_waitcnt lgkmcnt(0)
    v_readfirstlane_b32 s34, v127
    s_cmp_ge_i32 s34, s83
    s_setprio 1
    s_cbranch_scc1 P2_pollr12
    s_branch P2_poll12
.section .rodata,"a"
.p2align 6
.amdhsa_kernel gather_scatter__molecular_angular_gemnet__graph_kernel
  .amdhsa_next_free_vgpr 128
  .amdhsa_next_free_sgpr 102
  .amdhsa_accum_offset 128
  .amdhsa_group_segment_fixed_size 0
  .amdhsa_kernarg_size 112
  .amdhsa_user_sgpr_count 2
  .amdhsa_user_sgpr_kernarg_segment_ptr 1
  .amdhsa_system_sgpr_workgroup_id_x 1
.end_amdhsa_kernel
```
